```python
import torch

def _softmax(x, axis=-1):
    return torch.softmax(x, dim=axis)
def _gelu(x):
    return torch.nn.functional.gelu(x, approximate="tanh")
def _silu(x):
    return torch.nn.functional.silu(x)
def _sigmoid(x):
    return torch.sigmoid(x)
def _layernorm(x, axis=-1, eps=1e-5):
    m = x.mean(dim=axis, keepdim=True)
    v = x.var(dim=axis, keepdim=True, unbiased=False)
    return (x - m) / torch.sqrt(v + eps)
def _scatter_add(tgt, idx, src, axis=0):
    return tgt.clone().index_add_(axis, idx, src)
def _segment_sum(src, seg, n):
    out = torch.zeros((n,) + src.shape[1:], dtype=src.dtype)
    return out.index_add_(0, seg, src)
def _pad(x, pw):
    flat = tuple(v for pair in reversed(pw) for v in pair)
    return torch.nn.functional.pad(x, flat)

kernel_name = 'gather_scatter__edge_featured_mpnn_gatedgcn__graph'

def setup_inputs():

    _w = (lambda a: (lambda t: t.to(torch.bfloat16) if t.is_floating_point() else t)(torch.as_tensor(a)))
    N, deg, D, De = 10000, 64, 64, max(16, 1)
    E = N * deg
    return {
        "x": _w((lambda *s: torch.randn(*s, dtype=torch.bfloat16) * 0.8)(N, D)),
        "e_attr": _w((lambda *s: torch.randn(*s, dtype=torch.bfloat16) * 0.8)(E, De)),
        "src": _w((lambda lo, hi, *s: torch.randint(lo, hi, s))(0, N, E).to(torch.int64)),
        "dst": _w((lambda lo, hi, *s: torch.randint(lo, hi, s))(0, N, E).to(torch.int64)),
        "w_a": _w((lambda *s: torch.randn(*s, dtype=torch.bfloat16) * 0.8)(D, D)),
        "w_b": _w((lambda *s: torch.randn(*s, dtype=torch.bfloat16) * 0.8)(D, D)),
        "w_c": _w((lambda *s: torch.randn(*s, dtype=torch.bfloat16) * 0.8)(De, D)),
        "w_u": _w((lambda *s: torch.randn(*s, dtype=torch.bfloat16) * 0.05)(D, D)),
        "w_v": _w((lambda *s: torch.randn(*s, dtype=torch.bfloat16) * 0.05)(D, D)),
    }

def reference(x, e_attr, src, dst, w_a, w_b, w_c, w_u, w_v):
    N, D = x.shape
    hv = x @ w_v
    g = x[dst] @ w_a + x[src] @ w_b + e_attr @ w_c
    eta = _sigmoid(g)
    denom = _segment_sum(eta, dst, N) + 1e-6
    eta_n = eta / denom[dst]
    agg = _segment_sum(eta_n * hv[src], dst, N)
    z = x @ w_u + agg
    relu_z = torch.where(z > 0, z, 0 * z)
    return x + relu_z
```

```asm
; @launch kernel=bin_kernel grid=(250,1,1) block=(640,1,1) lds=42240
; @launch kernel=gather_scatter__edge_featured_mpnn_gatedgcn__graph_kernel grid=(250,1,1) block=(512,1,1) lds=161280
.amdgcn_target "amdgcn-amd-amdhsa--gfx950"
.text
.globl bin_kernel
.p2align 8
.type bin_kernel,@function
bin_kernel:
s_cmp_ge_u32 s2, 250
s_cbranch_scc1 K1_end
s_load_dwordx4 s[4:7], s[0:1], 16
s_load_dwordx2 s[8:9], s[0:1], 88
s_load_dwordx8 s[40:47], s[0:1], 32
s_load_dwordx2 s[48:49], s[0:1], 64
v_lshlrev_b32 v1, 4, v0
v_mov_b32 v4, -1
v_mov_b32 v5, -1
v_mov_b32 v6, -1
v_mov_b32 v7, -1
ds_write_b128 v1, v[4:7] offset:0
ds_write_b128 v1, v[4:7] offset:10240
ds_write_b128 v1, v[4:7] offset:20480
ds_write_b128 v1, v[4:7] offset:30720
v_mov_b32 v8, 0
v_mov_b32 v9, 0
v_mov_b32 v10, 0
v_mov_b32 v11, 0
v_and_b32 v2, 0x3ff, v1
ds_write_b128 v2, v[8:11] offset:40960
s_mul_i32 s20, s2, 10240
v_add_u32 v3, s20, v1
v_lshrrev_b32 v36, 6, v0
s_nop 0
v_readfirstlane_b32 s38, v36
s_waitcnt lgkmcnt(0)
s_mov_b32 s12, s4
s_and_b32 s13, s5, 0xffff
s_mov_b32 s14, 2560000
s_mov_b32 s15, 0x20000
s_mov_b32 s16, s6
s_and_b32 s17, s7, 0xffff
s_mov_b32 s18, 2560000
s_mov_b32 s19, 0x20000
s_mov_b32 s24, s8
s_and_b32 s25, s9, 0xffff
s_mov_b32 s26, 8000000
s_mov_b32 s27, 0x20000
buffer_load_dwordx4 v[12:15], v3, s[16:19], 0 offen
buffer_load_dwordx4 v[16:19], v3, s[12:15], 0 offen
s_mov_b32 s39, 0
s_cmp_lg_u32 s38, 9
s_cbranch_scc1 K1_now
s_cmp_ge_u32 s2, 34
s_cbranch_scc1 K1_now
s_mov_b32 s39, 1
s_mov_b32 s54, 0xbfb8aa3b
s_mov_b32 s55, 8192
s_mov_b32 s56, 0
s_mov_b32 s52, s42
s_mov_b32 s53, s43
s_cmp_lt_u32 s2, 8
s_cbranch_scc1 K1_wsel
s_mov_b32 s52, s48
s_mov_b32 s53, s49
s_mov_b32 s54, 1.0
s_mov_b32 s56, 8
s_cmp_lt_u32 s2, 16
s_cbranch_scc1 K1_wsel
s_mov_b32 s52, s44
s_mov_b32 s53, s45
s_mov_b32 s54, 0xbfb8aa3b
s_mov_b32 s55, 2048
s_mov_b32 s56, 16
s_cmp_lt_u32 s2, 18
s_cbranch_scc1 K1_wsel
s_mov_b32 s52, s40
s_mov_b32 s53, s41
s_mov_b32 s55, 8192
s_mov_b32 s56, 18
s_cmp_lt_u32 s2, 26
s_cbranch_scc1 K1_wsel
s_mov_b32 s52, s46
s_mov_b32 s53, s47
s_mov_b32 s54, 1.0
s_mov_b32 s56, 26
K1_wsel:
s_and_b32 s53, s53, 0xffff
s_mov_b32 s57, s55
s_mov_b32 s58, s57
s_mov_b32 s60, s52
s_mov_b32 s61, s53
s_mov_b32 s62, s55
s_mov_b32 s63, 0x20000
s_sub_u32 s57, s2, s56
v_and_b32 v37, 31, v0
v_bfe_u32 v38, v0, 5, 1
s_cmp_eq_u32 s55, 2048
s_cbranch_scc1 K1_wc
s_lshr_b32 s58, s57, 2
s_and_b32 s59, s57, 3
s_lshl_b32 s59, s59, 10
s_lshl_b32 s58, s58, 6
s_add_u32 s58, s58, s59
v_lshlrev_b32 v38, 12, v38
s_branch K1_wgo
K1_wc:
s_lshl_b32 s58, s57, 6
v_lshlrev_b32 v38, 10, v38
K1_wgo:
v_lshl_add_u32 v37, v37, 1, v38
buffer_load_ushort v40, v37, s[60:63], s58 offen offset:0
buffer_load_ushort v41, v37, s[60:63], s58 offen offset:128
buffer_load_ushort v42, v37, s[60:63], s58 offen offset:256
buffer_load_ushort v43, v37, s[60:63], s58 offen offset:384
buffer_load_ushort v44, v37, s[60:63], s58 offen offset:512
buffer_load_ushort v45, v37, s[60:63], s58 offen offset:640
buffer_load_ushort v46, v37, s[60:63], s58 offen offset:768
buffer_load_ushort v47, v37, s[60:63], s58 offen offset:896
K1_now:
s_barrier
s_mov_b32 s21, 52429
s_mov_b32 s22, -40
v_lshlrev_b32 v2, 2, v0
v_mov_b32 v20, 1
s_cmp_eq_u32 s39, 0
s_cbranch_scc1 K1_wa
s_waitcnt vmcnt(9)
s_branch K1_wb
K1_wa:
s_waitcnt vmcnt(1)
K1_wb:
v_mul_u32_u24 v24, s21, v12
v_lshrrev_b32 v24, 21, v24
v_lshlrev_b32 v28, 2, v24
ds_add_rtn_u32 v32, v28, v20 offset:40960
v_mad_i32_i24 v12, v24, s22, v12
v_mul_u32_u24 v25, s21, v13
v_lshrrev_b32 v25, 21, v25
v_lshlrev_b32 v29, 2, v25
ds_add_rtn_u32 v33, v29, v20 offset:40960
v_mad_i32_i24 v13, v25, s22, v13
v_mul_u32_u24 v26, s21, v14
v_lshrrev_b32 v26, 21, v26
v_lshlrev_b32 v30, 2, v26
ds_add_rtn_u32 v34, v30, v20 offset:40960
v_mad_i32_i24 v14, v26, s22, v14
v_mul_u32_u24 v27, s21, v15
v_lshrrev_b32 v27, 21, v27
v_lshlrev_b32 v31, 2, v27
ds_add_rtn_u32 v35, v31, v20 offset:40960
v_mad_i32_i24 v15, v27, s22, v15
s_cmp_eq_u32 s39, 0
s_cbranch_scc1 K1_wc2
s_waitcnt vmcnt(8)
s_branch K1_wd
K1_wc2:
s_waitcnt vmcnt(0)
K1_wd:
v_add_u32 v21, 0, v2
v_lshl_or_b32 v21, v16, 12, v21
v_lshl_or_b32 v16, v12, 26, v21
v_add_u32 v21, 1, v2
v_lshl_or_b32 v21, v17, 12, v21
v_lshl_or_b32 v17, v13, 26, v21
v_add_u32 v21, 2, v2
v_lshl_or_b32 v21, v18, 12, v21
v_lshl_or_b32 v18, v14, 26, v21
v_add_u32 v21, 3, v2
v_lshl_or_b32 v21, v19, 12, v21
v_lshl_or_b32 v19, v15, 26, v21
s_waitcnt lgkmcnt(0)
v_mov_b32 v23, 144
v_mov_b32 v22, 42236
v_lshlrev_b32 v21, 2, v32
v_mad_u32_u24 v24, v24, v23, v21
v_cmp_gt_u32 vcc, 32, v32
s_nop 1
v_cndmask_b32 v24, v22, v24, vcc
ds_write_b32 v24, v16
v_lshlrev_b32 v21, 2, v33
v_mad_u32_u24 v25, v25, v23, v21
v_cmp_gt_u32 vcc, 32, v33
s_nop 1
v_cndmask_b32 v25, v22, v25, vcc
ds_write_b32 v25, v17
v_lshlrev_b32 v21, 2, v34
v_mad_u32_u24 v26, v26, v23, v21
v_cmp_gt_u32 vcc, 32, v34
s_nop 1
v_cndmask_b32 v26, v22, v26, vcc
ds_write_b32 v26, v18
v_lshlrev_b32 v21, 2, v35
v_mad_u32_u24 v27, v27, v23, v21
v_cmp_gt_u32 vcc, 32, v35
s_nop 1
v_cndmask_b32 v27, v22, v27, vcc
ds_write_b32 v27, v19
s_waitcnt lgkmcnt(0)
s_barrier
v_lshrrev_b32 v2, 2, v0
v_and_b32 v3, 3, v0
v_lshlrev_b32 v4, 2, v2
v_lshlrev_b32 v1, 4, v3
v_mad_u32_u24 v1, v2, v23, v1
ds_read_b128 v[12:15], v1 offset:0
ds_read_b32 v28, v4 offset:40960
ds_read_b128 v[16:19], v1 offset:23040
ds_read_b32 v29, v4 offset:41600
ds_read_b128 v[20:23], v1 offset:64
ds_read_b128 v[32:35], v1 offset:23104
s_mov_b32 s23, 16000
v_mul_lo_u32 v5, v2, s23
v_lshl_add_u32 v5, v3, 4, v5
s_lshl_b32 s20, s2, 6
s_mov_b32 s26, 4000000
s_add_u32 s72, s8, 4000000
s_addc_u32 s73, s9, 0
s_and_b32 s73, s73, 0xffff
s_mov_b32 s74, 4000000
s_mov_b32 s75, 0x20000
v_cmp_eq_u32 s[30:31], 3, v3
v_mov_b32 v6, -2
s_waitcnt lgkmcnt(4)
s_add_u32 s21, s20, 0
buffer_store_dwordx4 v[12:15], v5, s[24:27], s21 offen sc1
s_waitcnt lgkmcnt(2)
s_add_u32 s21, s20, 2560000
buffer_store_dwordx4 v[16:19], v5, s[24:27], s21 offen sc1
s_waitcnt lgkmcnt(0)
v_cmp_lt_u32 vcc, 32, v28
s_nop 1
s_and_b64 vcc, vcc, s[30:31]
s_nop 1
v_cndmask_b32 v23, v23, v6, vcc
v_cmp_le_u32 vcc, 16, v28
s_and_saveexec_b64 s[76:77], vcc
s_cbranch_execz K1_sec0
s_add_u32 s21, s20, 0
buffer_store_dwordx4 v[20:23], v5, s[72:75], s21 offen sc1
K1_sec0:
s_mov_b64 exec, s[76:77]
v_cmp_lt_u32 vcc, 32, v29
s_nop 1
s_and_b64 vcc, vcc, s[30:31]
s_nop 1
v_cndmask_b32 v35, v35, v6, vcc
v_cmp_le_u32 vcc, 16, v29
s_and_saveexec_b64 s[76:77], vcc
s_cbranch_execz K1_sec1
s_add_u32 s21, s20, 2560000
buffer_store_dwordx4 v[32:35], v5, s[72:75], s21 offen sc1
K1_sec1:
s_mov_b64 exec, s[76:77]
s_cmp_eq_u32 s39, 0
s_cbranch_scc1 K1_fin
s_add_u32 s60, s8, 8000000
s_addc_u32 s61, s9, 0
s_and_b32 s61, s61, 0xffff
s_mov_b32 s62, 34816
s_mov_b32 s63, 0x20000
s_waitcnt vmcnt(0)
v_lshlrev_b32 v40, 16, v40
v_mul_f32 v40, s54, v40
v_lshlrev_b32 v41, 16, v41
v_mul_f32 v41, s54, v41
v_lshlrev_b32 v42, 16, v42
v_mul_f32 v42, s54, v42
v_lshlrev_b32 v43, 16, v43
v_mul_f32 v43, s54, v43
v_lshlrev_b32 v44, 16, v44
v_mul_f32 v44, s54, v44
v_lshlrev_b32 v45, 16, v45
v_mul_f32 v45, s54, v45
v_lshlrev_b32 v46, 16, v46
v_mul_f32 v46, s54, v46
v_lshlrev_b32 v47, 16, v47
v_mul_f32 v47, s54, v47
v_cvt_pk_bf16_f32 v40, v40, v41
v_cvt_pk_bf16_f32 v41, v42, v43
v_cvt_pk_bf16_f32 v42, v44, v45
v_cvt_pk_bf16_f32 v43, v46, v47
v_and_b32 v37, 63, v0
v_lshlrev_b32 v37, 4, v37
s_lshl_b32 s58, s2, 10
buffer_store_dwordx4 v[40:43], v37, s[60:63], s58 offen sc1
K1_fin:
K1_end:
s_endpgm
.section .rodata,"a"
.p2align 6
.amdhsa_kernel bin_kernel
  .amdhsa_next_free_vgpr 52
  .amdhsa_next_free_sgpr 88
  .amdhsa_accum_offset 52
  .amdhsa_group_segment_fixed_size 0
  .amdhsa_kernarg_size 96
  .amdhsa_user_sgpr_count 2
  .amdhsa_user_sgpr_kernarg_segment_ptr 1
  .amdhsa_system_sgpr_workgroup_id_x 1
  .amdhsa_float_denorm_mode_32 3
.end_amdhsa_kernel
.text
.text
.globl gather_scatter__edge_featured_mpnn_gatedgcn__graph_kernel
.p2align 8
.type gather_scatter__edge_featured_mpnn_gatedgcn__graph_kernel,@function
gather_scatter__edge_featured_mpnn_gatedgcn__graph_kernel:
s_cmp_ge_u32 s2, 250
s_cbranch_scc1 K2_end
s_load_dwordx2 s[26:27], s[0:1], 88
s_load_dwordx4 s[4:7], s[0:1], 0
s_load_dwordx4 s[8:11], s[0:1], 16
s_load_dwordx4 s[20:23], s[0:1], 64
s_load_dwordx2 s[24:25], s[0:1], 80
v_lshlrev_b32 v36, 4, v0
s_mul_i32 s60, s2, 16000
s_add_u32 s61, s60, 8192
v_mov_b32 v196, -1
v_mov_b32 v197, -1
v_mov_b32 v198, -1
v_mov_b32 v199, -1
v_mov_b32 v200, -1
v_mov_b32 v201, -1
v_mov_b32 v202, -1
v_mov_b32 v203, -1
v_mov_b32 v204, -1
v_mov_b32 v205, -1
v_mov_b32 v206, -1
v_mov_b32 v207, -1
v_lshrrev_b32 v1, 6, v0
v_and_b32 v2, 63, v0
v_readfirstlane_b32 s52, v1
s_mul_i32 s58, s2, 40
s_mov_b32 s12, 40
v_cmp_gt_u32 vcc, 488, v0
s_waitcnt lgkmcnt(0)
s_mov_b32 s36, s26
s_and_b32 s37, s27, 0xffff
s_mov_b32 s38, 4000000
s_mov_b32 s39, 0x20000
buffer_load_dwordx4 v[192:195], v36, s[36:39], s60 offen
s_and_saveexec_b64 s[62:63], vcc
buffer_load_dwordx4 v[196:199], v36, s[36:39], s61 offen
s_mov_b64 exec, s[62:63]
s_add_u32 s44, s26, 4000000
s_addc_u32 s45, s27, 0
s_and_b32 s45, s45, 0xffff
s_mov_b32 s46, 4000000
s_mov_b32 s47, 0x20000
v_mov_b32 v25, v36
s_add_u32 s64, s26, 8000000
s_addc_u32 s65, s27, 0
s_and_b32 s65, s65, 0xffff
s_mov_b32 s66, 34816
s_mov_b32 s67, 0x20000
s_mov_b32 s28, s4
s_and_b32 s29, s5, 0xffff
s_mov_b32 s30, 1280000
s_mov_b32 s31, 0x20000
v_and_b32 v211, 31, v2
v_lshrrev_b32 v212, 5, v2
s_mov_b32 s32, s6
s_and_b32 s33, s7, 0xffff
s_mov_b32 s34, 20480000
s_mov_b32 s35, 0x20000
s_mov_b32 s40, s22
s_and_b32 s41, s23, 0xffff
s_mov_b32 s42, 1280000
s_mov_b32 s43, 0x20000
s_add_u32 s42, s58, s12
s_lshl_b32 s42, s42, 7
v_lshlrev_b32 v1, 4, v0
s_cmp_gt_u32 s52, 2
s_cbranch_scc1 Li_1
v_mov_b32 v56, 0x50005000
v_cmp_gt_u32 vcc, 32, v0
s_nop 1
v_cndmask_b32_e64 v56, v56, 0, vcc
v_mov_b32 v57, v56
v_mov_b32 v58, v56
v_mov_b32 v59, v56
v_cmp_gt_u32 vcc, 160, v0
s_and_saveexec_b64 s[62:63], vcc
ds_write_b128 v1, v[56:59] offset:0
s_mov_b64 exec, s[62:63]
Li_1:
s_cmp_lg_u32 s52, 3
s_cbranch_scc1 Li_2
v_lshlrev_b32 v15, 2, v2
v_mov_b32 v56, 0x1fff80
v_mov_b32 v57, 0x40000000
v_mov_b32 v58, 0
v_add_u32 v16, 20480, v15
ds_write2st64_b32 v16, v56, v57 offset0:10 offset1:94
ds_write_b32 v16, v58 offset:45568
Li_2:
v_lshrrev_b32 v208, 3, v2
v_and_b32 v209, 7, v2
v_lshrrev_b32 v210, 1, v208
v_xor_b32 v210, v210, v209
v_lshlrev_b32 v3, 4, v210
v_xor_b32 v4, 64, v3
v_and_b32 v210, 3, v208
v_lshlrev_b32 v5, 4, v210
v_lshlrev_b32 v12, 2, v211
v_add_u32 v37, 66560, v12
v_lshlrev_b32 v11, 4, v212
v_and_b32 v213, 3, v211
v_lshlrev_b32 v213, 2, v213
v_lshrrev_b32 v214, 3, v211
v_add_u32 v213, v213, v214
v_lshlrev_b32 v10, 2, v213
s_lshl_b32 s53, s52, 13
s_add_u32 s53, s53, 95744
v_lshrrev_b32 v213, 1, v211
v_and_b32 v213, 7, v213
v_lshlrev_b32 v214, 2, v212
v_add_u32 v215, 0, v214
v_xor_b32 v215, v215, v213
v_lshlrev_b32 v215, 4, v215
v_lshl_add_u32 v215, v211, 7, v215
v_add_u32 v6, s53, v215
v_add_u32 v215, 1, v214
v_xor_b32 v215, v215, v213
v_lshlrev_b32 v215, 4, v215
v_lshl_add_u32 v215, v211, 7, v215
v_add_u32 v7, s53, v215
v_add_u32 v215, 2, v214
v_xor_b32 v215, v215, v213
v_lshlrev_b32 v215, 4, v215
v_lshl_add_u32 v215, v211, 7, v215
v_add_u32 v8, s53, v215
v_add_u32 v215, 3, v214
v_xor_b32 v215, v215, v213
v_lshlrev_b32 v215, 4, v215
v_lshl_add_u32 v215, v211, 7, v215
v_add_u32 v9, s53, v215
v_bfe_u32 v213, v211, 2, 1
v_cmp_eq_u32 vcc, v212, v213
v_mov_b32 v214, 0x3f803f80
v_mov_b32 v65, 0
v_cndmask_b32 v64, 0, v214, vcc
v_mov_b32 v66, 0
v_mov_b32 v67, 0
v_mov_b32 v69, 0x7149
v_mov_b32 v71, 0x7149
v_mov_b32 v72, 0
v_mov_b32 v73, 0
v_mov_b32 v22, 0x7e00
v_mov_b32 v23, 0x7fc0
v_mov_b32 v24, 0x1fff80
v_mov_b32 v40, 0
v_mov_b32 v41, 0
v_mov_b32 v42, 0
v_mov_b32 v43, 0
v_mov_b32 v44, 0
v_mov_b32 v45, 0
v_mov_b32 v46, 0
v_mov_b32 v47, 0
v_mov_b32 v48, 0
v_mov_b32 v49, 0
v_mov_b32 v50, 0
v_mov_b32 v51, 0
v_mov_b32 v52, 0
v_mov_b32 v53, 0
v_mov_b32 v54, 0
v_mov_b32 v55, 0
v_lshrrev_b32 v17, 2, v0
s_mov_b32 s60, 81920
v_mul_lo_u32 v15, v17, s60
v_add_u32 v16, 10485760, v15
v_mov_b32 v19, 0xfc
v_mov_b32 v20, 4
s_movk_i32 s60, 160
s_mov_b32 s55, 0
s_mov_b32 s56, 0
s_mov_b32 s57, 0
s_waitcnt lgkmcnt(0)
s_barrier
s_waitcnt vmcnt(0)
s_mul_i32 s61, s2, 16000
v_mov_b32_dpp v35, v195 quad_perm:[3,3,3,3] row_mask:0xf bank_mask:0xf
v_cmp_gt_u32 vcc, 0xa0000000, v35
s_nop 0
s_mov_b64 s[96:97], vcc
s_cbranch_vccz Lsl_3
s_mov_b64 exec, vcc
buffer_load_dwordx4 v[200:203], v25, s[44:47], s61 offen
s_mov_b64 exec, -1
Lsl_3:
s_add_u32 s61, s61, 8192
v_mov_b32_dpp v35, v199 quad_perm:[3,3,3,3] row_mask:0xf bank_mask:0xf
v_cmp_gt_u32 vcc, 0xa0000000, v35
s_nop 0
s_mov_b64 s[98:99], vcc
s_cbranch_vccz Lsl_4
s_mov_b64 exec, vcc
buffer_load_dwordx4 v[204:207], v25, s[44:47], s61 offen
s_mov_b64 exec, -1
Lsl_4:
v_mov_b32 v21, 60
v_and_b32_sdwa v208, v192, v19 dst_sel:DWORD dst_unused:UNUSED_PAD src0_sel:BYTE_3 src1_sel:DWORD
v_cmp_gt_u32 s[68:69], s60, v208
s_mov_b64 exec, s[68:69]
ds_add_rtn_u32 v224, v208, v20 offset:0
s_mov_b64 exec, -1
v_and_b32_sdwa v209, v193, v19 dst_sel:DWORD dst_unused:UNUSED_PAD src0_sel:BYTE_3 src1_sel:DWORD
v_cmp_gt_u32 s[70:71], s60, v209
s_mov_b64 exec, s[70:71]
ds_add_rtn_u32 v225, v209, v20 offset:0
s_mov_b64 exec, -1
v_and_b32_sdwa v210, v194, v19 dst_sel:DWORD dst_unused:UNUSED_PAD src0_sel:BYTE_3 src1_sel:DWORD
v_cmp_gt_u32 s[72:73], s60, v210
s_mov_b64 exec, s[72:73]
ds_add_rtn_u32 v226, v210, v20 offset:0
s_mov_b64 exec, -1
v_and_b32_sdwa v211, v195, v19 dst_sel:DWORD dst_unused:UNUSED_PAD src0_sel:BYTE_3 src1_sel:DWORD
v_cmp_gt_u32 s[74:75], s60, v211
s_mov_b64 exec, s[74:75]
ds_add_rtn_u32 v227, v211, v20 offset:0
s_mov_b64 exec, -1
v_and_b32_sdwa v212, v196, v19 dst_sel:DWORD dst_unused:UNUSED_PAD src0_sel:BYTE_3 src1_sel:DWORD
v_cmp_gt_u32 s[76:77], s60, v212
s_mov_b64 exec, s[76:77]
ds_add_rtn_u32 v228, v212, v20 offset:0
s_mov_b64 exec, -1
v_and_b32_sdwa v213, v197, v19 dst_sel:DWORD dst_unused:UNUSED_PAD src0_sel:BYTE_3 src1_sel:DWORD
v_cmp_gt_u32 s[78:79], s60, v213
s_mov_b64 exec, s[78:79]
ds_add_rtn_u32 v229, v213, v20 offset:0
s_mov_b64 exec, -1
v_and_b32_sdwa v214, v198, v19 dst_sel:DWORD dst_unused:UNUSED_PAD src0_sel:BYTE_3 src1_sel:DWORD
v_cmp_gt_u32 s[80:81], s60, v214
s_mov_b64 exec, s[80:81]
ds_add_rtn_u32 v230, v214, v20 offset:0
s_mov_b64 exec, -1
v_and_b32_sdwa v215, v199, v19 dst_sel:DWORD dst_unused:UNUSED_PAD src0_sel:BYTE_3 src1_sel:DWORD
v_cmp_gt_u32 s[82:83], s60, v215
s_mov_b64 exec, s[82:83]
ds_add_rtn_u32 v231, v215, v20 offset:0
s_mov_b64 exec, -1
v_lshrrev_b32 v160, 5, v192
v_and_b32 v192, 0xfff, v192
v_lshl_add_u32 v192, v192, 5, v15
v_lshrrev_b32 v161, 5, v193
v_and_b32 v193, 0xfff, v193
v_lshl_add_u32 v193, v193, 5, v15
v_lshrrev_b32 v162, 5, v194
v_and_b32 v194, 0xfff, v194
v_lshl_add_u32 v194, v194, 5, v15
v_lshrrev_b32 v163, 5, v195
v_and_b32 v195, 0xfff, v195
v_lshl_add_u32 v195, v195, 5, v15
v_lshrrev_b32 v164, 5, v196
v_and_b32 v196, 0xfff, v196
v_lshl_add_u32 v196, v196, 5, v16
v_lshrrev_b32 v165, 5, v197
v_and_b32 v197, 0xfff, v197
v_lshl_add_u32 v197, v197, 5, v16
v_lshrrev_b32 v166, 5, v198
v_and_b32 v198, 0xfff, v198
v_lshl_add_u32 v198, v198, 5, v16
v_lshrrev_b32 v167, 5, v199
v_and_b32 v199, 0xfff, v199
v_lshl_add_u32 v199, v199, 5, v16
v_and_b32 v2, 63, v0
v_lshlrev_b32 v35, 4, v2
s_lshl_b32 s61, s52, 10
s_add_u32 m0, s61, 66560
s_nop 0
buffer_load_dwordx4 v35, s[64:67], s61 offen lds
s_add_u32 s61, s61, 8192
s_add_u32 m0, s61, 66560
s_nop 0
buffer_load_dwordx4 v35, s[64:67], s61 offen lds
s_cmp_gt_u32 s52, 1
s_cbranch_scc1 Lw3_5
s_add_u32 s61, s61, 8192
s_add_u32 m0, s61, 66560
s_nop 0
buffer_load_dwordx4 v35, s[64:67], s61 offen lds
Lw3_5:
s_lshr_b32 s61, s52, 2
s_lshl_b32 s61, s61, 13
s_bfe_u32 s62, s52, 0x10001
s_lshl_b32 s62, s62, 12
s_add_u32 s61, s61, s62
s_add_u32 s61, s61, 18432
s_and_b32 s62, s52, 1
s_lshl_b32 s62, s62, 11
s_add_u32 s61, s61, s62
s_lshr_b32 s63, s52, 1
s_lshl_b32 s63, s63, 14
s_add_u32 s63, s63, s62
s_add_u32 m0, s63, 99840
s_nop 0
buffer_load_dwordx4 v35, s[64:67], s61 offen lds
s_add_u32 m0, s63, 100864
s_add_u32 s61, s61, 1024
buffer_load_dwordx4 v35, s[64:67], s61 offen lds
v_lshrrev_b32 v36, 3, v2
v_lshrrev_b32 v18, 1, v36
v_and_b32 v17, 7, v2
v_xor_b32 v18, v18, v17
v_lshlrev_b32 v18, 4, v18
s_lshl_b32 s61, s52, 3
s_add_u32 s62, s61, s58
v_add_u32 v36, s62, v36
v_lshlrev_b32 v36, 7, v36
s_and_b32 s62, s52, 1
s_lshl_b32 s62, s62, 6
v_xor_b32 v18, s62, v18
v_add_u32 v36, v36, v18
s_lshl_b32 s61, s52, 10
s_add_u32 m0, s61, 84992
s_nop 0
buffer_load_dwordx4 v36, s[28:31], 0 offen lds
s_waitcnt lgkmcnt(0)
v_min_u32 v224, 508, v224
v_bitop3_b32 v224, v224, v208, v21 bitop3:0x78
v_lshl_add_u32 v208, v208, 7, v224
s_mov_b64 exec, s[68:69]
ds_write2st64_b32 v208, v160, v192 offset0:10 offset1:94
s_mov_b64 exec, -1
v_min_u32 v225, 508, v225
v_bitop3_b32 v225, v225, v209, v21 bitop3:0x78
v_lshl_add_u32 v209, v209, 7, v225
s_mov_b64 exec, s[70:71]
ds_write2st64_b32 v209, v161, v193 offset0:10 offset1:94
s_mov_b64 exec, -1
v_min_u32 v226, 508, v226
v_bitop3_b32 v226, v226, v210, v21 bitop3:0x78
v_lshl_add_u32 v210, v210, 7, v226
s_mov_b64 exec, s[72:73]
ds_write2st64_b32 v210, v162, v194 offset0:10 offset1:94
s_mov_b64 exec, -1
v_min_u32 v227, 508, v227
v_bitop3_b32 v227, v227, v211, v21 bitop3:0x78
v_lshl_add_u32 v211, v211, 7, v227
s_mov_b64 exec, s[74:75]
ds_write2st64_b32 v211, v163, v195 offset0:10 offset1:94
s_mov_b64 exec, -1
v_min_u32 v228, 508, v228
v_bitop3_b32 v228, v228, v212, v21 bitop3:0x78
v_lshl_add_u32 v212, v212, 7, v228
s_mov_b64 exec, s[76:77]
ds_write2st64_b32 v212, v164, v196 offset0:10 offset1:94
s_mov_b64 exec, -1
v_min_u32 v229, 508, v229
v_bitop3_b32 v229, v229, v213, v21 bitop3:0x78
v_lshl_add_u32 v213, v213, 7, v229
s_mov_b64 exec, s[78:79]
ds_write2st64_b32 v213, v165, v197 offset0:10 offset1:94
s_mov_b64 exec, -1
v_min_u32 v230, 508, v230
v_bitop3_b32 v230, v230, v214, v21 bitop3:0x78
v_lshl_add_u32 v214, v214, 7, v230
s_mov_b64 exec, s[80:81]
ds_write2st64_b32 v214, v166, v198 offset0:10 offset1:94
s_mov_b64 exec, -1
v_min_u32 v231, 508, v231
v_bitop3_b32 v231, v231, v215, v21 bitop3:0x78
v_lshl_add_u32 v215, v215, 7, v231
s_mov_b64 exec, s[82:83]
ds_write2st64_b32 v215, v167, v199 offset0:10 offset1:94
s_mov_b64 exec, -1
s_or_b64 s[62:63], s[96:97], s[98:99]
s_cmp_eq_u64 s[62:63], 0
s_cbranch_scc1 Lns_6
s_waitcnt vmcnt(5)
s_movk_i32 s60, 160
v_cmp_eq_u32 vcc, -2, v203
v_cmp_eq_u32 s[62:63], -2, v207
s_nop 1
s_or_b64 vcc, vcc, s[62:63]
s_cbranch_vccz Lov_7
v_mov_b32 v18, 244
ds_write_b32 v18, v20
Lov_7:
s_cmp_eq_u64 s[96:97], 0
s_cbranch_scc1 Lsp_8
v_and_b32_sdwa v216, v200, v19 dst_sel:DWORD dst_unused:UNUSED_PAD src0_sel:BYTE_3 src1_sel:DWORD
v_cmp_gt_u32 s[84:85], s60, v216
s_mov_b64 exec, s[84:85]
ds_add_rtn_u32 v232, v216, v20 offset:0
s_mov_b64 exec, -1
v_and_b32_sdwa v217, v201, v19 dst_sel:DWORD dst_unused:UNUSED_PAD src0_sel:BYTE_3 src1_sel:DWORD
v_cmp_gt_u32 s[86:87], s60, v217
s_mov_b64 exec, s[86:87]
ds_add_rtn_u32 v233, v217, v20 offset:0
s_mov_b64 exec, -1
v_and_b32_sdwa v218, v202, v19 dst_sel:DWORD dst_unused:UNUSED_PAD src0_sel:BYTE_3 src1_sel:DWORD
v_cmp_gt_u32 s[88:89], s60, v218
s_mov_b64 exec, s[88:89]
ds_add_rtn_u32 v234, v218, v20 offset:0
s_mov_b64 exec, -1
v_and_b32_sdwa v219, v203, v19 dst_sel:DWORD dst_unused:UNUSED_PAD src0_sel:BYTE_3 src1_sel:DWORD
v_cmp_gt_u32 s[90:91], s60, v219
s_mov_b64 exec, s[90:91]
ds_add_rtn_u32 v235, v219, v20 offset:0
s_mov_b64 exec, -1
v_lshrrev_b32 v168, 5, v200
v_and_b32 v200, 0xfff, v200
v_lshl_add_u32 v200, v200, 5, v15
v_lshrrev_b32 v169, 5, v201
v_and_b32 v201, 0xfff, v201
v_lshl_add_u32 v201, v201, 5, v15
v_lshrrev_b32 v170, 5, v202
v_and_b32 v202, 0xfff, v202
v_lshl_add_u32 v202, v202, 5, v15
v_lshrrev_b32 v171, 5, v203
v_and_b32 v203, 0xfff, v203
v_lshl_add_u32 v203, v203, 5, v15
s_waitcnt lgkmcnt(0)
v_min_u32 v232, 508, v232
v_bitop3_b32 v232, v232, v216, v21 bitop3:0x78
v_lshl_add_u32 v216, v216, 7, v232
s_mov_b64 exec, s[84:85]
ds_write2st64_b32 v216, v168, v200 offset0:10 offset1:94
s_mov_b64 exec, -1
v_min_u32 v233, 508, v233
v_bitop3_b32 v233, v233, v217, v21 bitop3:0x78
v_lshl_add_u32 v217, v217, 7, v233
s_mov_b64 exec, s[86:87]
ds_write2st64_b32 v217, v169, v201 offset0:10 offset1:94
s_mov_b64 exec, -1
v_min_u32 v234, 508, v234
v_bitop3_b32 v234, v234, v218, v21 bitop3:0x78
v_lshl_add_u32 v218, v218, 7, v234
s_mov_b64 exec, s[88:89]
ds_write2st64_b32 v218, v170, v202 offset0:10 offset1:94
s_mov_b64 exec, -1
v_min_u32 v235, 508, v235
v_bitop3_b32 v235, v235, v219, v21 bitop3:0x78
v_lshl_add_u32 v219, v219, 7, v235
s_mov_b64 exec, s[90:91]
ds_write2st64_b32 v219, v171, v203 offset0:10 offset1:94
s_mov_b64 exec, -1
Lsp_8:
s_cmp_eq_u64 s[98:99], 0
s_cbranch_scc1 Lsp_9
v_and_b32_sdwa v220, v204, v19 dst_sel:DWORD dst_unused:UNUSED_PAD src0_sel:BYTE_3 src1_sel:DWORD
v_cmp_gt_u32 s[92:93], s60, v220
s_mov_b64 exec, s[92:93]
ds_add_rtn_u32 v236, v220, v20 offset:0
s_mov_b64 exec, -1
v_and_b32_sdwa v221, v205, v19 dst_sel:DWORD dst_unused:UNUSED_PAD src0_sel:BYTE_3 src1_sel:DWORD
v_cmp_gt_u32 s[94:95], s60, v221
s_mov_b64 exec, s[94:95]
ds_add_rtn_u32 v237, v221, v20 offset:0
s_mov_b64 exec, -1
v_and_b32_sdwa v222, v206, v19 dst_sel:DWORD dst_unused:UNUSED_PAD src0_sel:BYTE_3 src1_sel:DWORD
v_cmp_gt_u32 s[96:97], s60, v222
s_mov_b64 exec, s[96:97]
ds_add_rtn_u32 v238, v222, v20 offset:0
s_mov_b64 exec, -1
v_and_b32_sdwa v223, v207, v19 dst_sel:DWORD dst_unused:UNUSED_PAD src0_sel:BYTE_3 src1_sel:DWORD
v_cmp_gt_u32 s[98:99], s60, v223
s_mov_b64 exec, s[98:99]
ds_add_rtn_u32 v239, v223, v20 offset:0
s_mov_b64 exec, -1
v_lshrrev_b32 v172, 5, v204
v_and_b32 v204, 0xfff, v204
v_lshl_add_u32 v204, v204, 5, v16
v_lshrrev_b32 v173, 5, v205
v_and_b32 v205, 0xfff, v205
v_lshl_add_u32 v205, v205, 5, v16
v_lshrrev_b32 v174, 5, v206
v_and_b32 v206, 0xfff, v206
v_lshl_add_u32 v206, v206, 5, v16
v_lshrrev_b32 v175, 5, v207
v_and_b32 v207, 0xfff, v207
v_lshl_add_u32 v207, v207, 5, v16
s_waitcnt lgkmcnt(0)
v_min_u32 v236, 508, v236
v_bitop3_b32 v236, v236, v220, v21 bitop3:0x78
v_lshl_add_u32 v220, v220, 7, v236
s_mov_b64 exec, s[92:93]
ds_write2st64_b32 v220, v172, v204 offset0:10 offset1:94
s_mov_b64 exec, -1
v_min_u32 v237, 508, v237
v_bitop3_b32 v237, v237, v221, v21 bitop3:0x78
v_lshl_add_u32 v221, v221, 7, v237
s_mov_b64 exec, s[94:95]
ds_write2st64_b32 v221, v173, v205 offset0:10 offset1:94
s_mov_b64 exec, -1
v_min_u32 v238, 508, v238
v_bitop3_b32 v238, v238, v222, v21 bitop3:0x78
v_lshl_add_u32 v222, v222, 7, v238
s_mov_b64 exec, s[96:97]
ds_write2st64_b32 v222, v174, v206 offset0:10 offset1:94
s_mov_b64 exec, -1
v_min_u32 v239, 508, v239
v_bitop3_b32 v239, v239, v223, v21 bitop3:0x78
v_lshl_add_u32 v223, v223, 7, v239
s_mov_b64 exec, s[98:99]
ds_write2st64_b32 v223, v175, v207 offset0:10 offset1:94
s_mov_b64 exec, -1
Lsp_9:
Lns_6:
L_build:
s_waitcnt lgkmcnt(0)
s_barrier
v_and_b32 v2, 63, v0
v_lshlrev_b32 v18, 2, v2
ds_read_b32 v19, v18 offset:0
s_waitcnt lgkmcnt(0)
v_readlane_b32 s60, v19, 61
v_cmp_gt_u32 vcc, 40, v2
s_movk_i32 s61, 512
s_nop 0
v_cndmask_b32 v19, 0, v19, vcc
v_cmp_lt_u32 vcc, s61, v19
s_nop 3
s_or_b32 s60, s60, vcc_lo
s_or_b32 s60, s60, vcc_hi
s_cmp_eq_u32 s60, 0
s_cbranch_scc1 L_noflag
s_cmp_lg_u32 s55, 0
s_cbranch_scc1 L_noflag
s_mov_b32 s55, 1
s_mov_b32 s56, 0
s_branch L_slowfill
L_noflag:
v_add_u32 v16, 60, v19
v_lshrrev_b32 v16, 6, v16
v_mov_b32 v17, v16
v_lshlrev_b32 v59, 6, v16
s_lshl_b32 s60, s52, 3
v_add_u32 v56, s60, v19
v_mov_b32 v57, 0x1fff80
v_mov_b32 v58, 0x40000000
v_cmpx_lt_u32 vcc, v56, v59
v_and_b32 v35, 60, v18
v_xor_b32 v35, v35, v56
v_lshl_add_u32 v15, v2, 9, v35
ds_write2st64_b32 v15, v57, v58 offset0:10 offset1:94
s_mov_b64 exec, -1
v_add_u32 v56, 4, v56
v_cmpx_lt_u32 vcc, v56, v59
v_and_b32 v35, 60, v18
v_xor_b32 v35, v35, v56
v_lshl_add_u32 v15, v2, 9, v35
ds_write2st64_b32 v15, v57, v58 offset0:10 offset1:94
s_mov_b64 exec, -1
v_add_u32_dpp v17, v17, v17 row_shr:1 row_mask:0xf bank_mask:0xf bound_ctrl:0
s_nop 1
v_add_u32_dpp v17, v17, v17 row_shr:2 row_mask:0xf bank_mask:0xf bound_ctrl:0
s_nop 1
v_add_u32_dpp v17, v17, v17 row_shr:4 row_mask:0xf bank_mask:0xf bound_ctrl:0
s_nop 1
v_add_u32_dpp v17, v17, v17 row_shr:8 row_mask:0xf bank_mask:0xf bound_ctrl:0
s_nop 1
v_add_u32_dpp v17, v17, v17 row_bcast:15 row_mask:0xa bank_mask:0xf
s_nop 1
v_add_u32_dpp v17, v17, v17 row_bcast:31 row_mask:0xc bank_mask:0xf
s_nop 1
v_readlane_b32 s59, v17, 63
v_sub_u32 v17, v17, v16
s_nop 3
s_lshr_b32 s62, s59, 4
s_and_b32 s63, s59, 15
s_add_u32 s60, s62, 1
s_mul_i32 s61, s60, s63
v_cvt_f32_u32 v20, s60
s_max_u32 s60, s62, 1
v_cvt_f32_u32 v35, s60
v_rcp_f32 v20, v20
v_rcp_f32 v35, v35
s_lshl_b32 s60, s52, 1
s_cmp_lt_u32 s60, s63
s_cselect_b32 s60, 1, 0
s_add_u32 s54, s62, s60
v_cvt_f32_u32 v21, v17
v_subrev_u32 v36, s61, v17
v_add_f32 v21, 0.5, v21
v_cvt_f32_u32 v36, v36
v_mul_f32 v21, v21, v20
v_add_f32 v36, 0.5, v36
v_cvt_u32_f32 v21, v21
v_mul_f32 v36, v36, v35
v_cmp_gt_u32 vcc, s61, v17
v_cvt_u32_f32 v36, v36
v_add_u32 v36, s63, v36
v_cndmask_b32 v21, v36, v21, vcc
s_cmp_lg_u32 s52, 0
s_cbranch_scc1 Lni_10
v_add_u32 v56, v17, v16
v_max_u32 v56, 1, v56
v_subrev_u32 v56, 1, v56
v_max_u32 v56, v56, v17
v_cvt_f32_u32 v57, v56
v_subrev_u32 v36, s61, v56
v_add_f32 v57, 0.5, v57
v_cvt_f32_u32 v36, v36
v_mul_f32 v57, v57, v20
v_add_f32 v36, 0.5, v36
v_cvt_u32_f32 v57, v57
v_mul_f32 v36, v36, v35
v_cmp_gt_u32 vcc, s61, v56
v_cvt_u32_f32 v36, v36
v_add_u32 v36, s63, v36
v_cndmask_b32 v57, v36, v57, vcc
v_lshl_or_b32 v56, v57, 8, v21
v_min_u32 v59, 1, v16
v_lshl_or_b32 v56, v59, 16, v56
ds_write_b32 v18, v56 offset:256
Lni_10:
v_cmpx_lt_u32 vcc, s52, v16
v_add_u32 v56, s52, v17
v_cvt_f32_u32 v57, v56
v_subrev_u32 v36, s61, v56
v_add_f32 v57, 0.5, v57
v_cvt_f32_u32 v36, v36
v_mul_f32 v57, v57, v20
v_add_f32 v36, 0.5, v36
v_cvt_u32_f32 v57, v57
v_mul_f32 v36, v36, v35
v_cmp_gt_u32 vcc, s61, v56
v_cvt_u32_f32 v36, v36
v_add_u32 v36, s63, v36
v_cndmask_b32 v57, v36, v57, vcc
v_mul_u32_u24 v58, s62, v57
v_min_u32 v59, s63, v57
v_add_u32 v58, v58, v59
v_sub_u32 v58, v56, v58
v_cmp_eq_u32 vcc, v57, v21
v_add_u32 v59, 41, v57
v_mov_b32 v56, s52
v_cndmask_b32 v59, v59, v2, vcc
v_cndmask_b32 v56, v58, v56, vcc
v_min_u32 v56, 1, v56
v_lshl_or_b32 v56, v59, 25, v56
v_lshl_or_b32 v56, v2, 9, v56
s_lshl_b32 s60, s52, 6
v_or_b32 v56, s60, v56
v_lshlrev_b32 v57, 7, v57
v_lshl_add_u32 v57, v58, 2, v57
ds_write_b32 v57, v56 offset:512
s_mov_b64 exec, -1
s_waitcnt lgkmcnt(0)
s_barrier
L_go:
s_lshl_b32 s60, s52, 8
s_add_u32 s60, s60, 512
v_bfe_u32 v35, v0, 5, 1
v_lshlrev_b32 v35, 7, v35
v_add_u32 v13, s60, v35
v_bfe_u32 v35, v0, 2, 1
v_lshlrev_b32 v35, 7, v35
v_add_u32 v14, s60, v35
s_setprio 3
s_cmp_eq_u32 s54, 0
s_cbranch_scc1 L_part1done
ds_read_b32 v15, v13 offset:0
ds_read_b32 v16, v14 offset:0
ds_read_b32 v17, v13 offset:0
s_waitcnt lgkmcnt(0)
v_and_or_b32 v19, v15, v23, v5
v_and_or_b32 v20, v16, v23, v10
ds_read_b128 v[56:59], v19 offset:2560
ds_read_b32 v18, v20 offset:24064
ds_read_b32 v15, v13 offset:4
ds_read_b32 v16, v14 offset:4
v_and_or_b32 v21, v17, v22, v12
v_add_u32_sdwa v25, v17, v37 dst_sel:DWORD dst_unused:UNUSED_PAD src0_sel:WORD_1 src1_sel:DWORD
v_bfe_i32 v27, v17, 0, 1
s_waitcnt lgkmcnt(0)
v_and_or_b32 v56, v56, v24, v3
v_and_or_b32 v57, v57, v24, v4
v_and_or_b32 v58, v58, v24, v3
v_and_or_b32 v59, v59, v24, v4
v_lshrrev_b32 v35, 30, v18
v_add_u32 v18, v18, v11
v_mul_u32_u24 v29, 0x3f80, v35
s_add_u32 m0, s53, 0
s_nop 0
buffer_load_dwordx4 v56, s[28:31], 0 offen lds
s_add_u32 m0, s53, 1024
s_nop 0
buffer_load_dwordx4 v57, s[28:31], 0 offen lds
s_add_u32 m0, s53, 2048
s_nop 0
buffer_load_dwordx4 v58, s[28:31], 0 offen lds
s_add_u32 m0, s53, 3072
s_nop 0
buffer_load_dwordx4 v59, s[28:31], 0 offen lds
buffer_load_dwordx4 v[148:151], v18, s[32:35], 0 offen
v_and_or_b32 v19, v15, v23, v5
v_and_or_b32 v20, v16, v23, v10
ds_read_b128 v[56:59], v19 offset:2560
ds_read_b32 v18, v20 offset:24064
ds_read_b32 v15, v13 offset:8
ds_read_b32 v16, v14 offset:8
L_part1done:
s_cmp_lg_u32 s57, 0
s_cbranch_scc1 Ljs_11
s_mov_b32 s57, 1
s_cmp_eq_u32 s54, 0
s_cbranch_scc1 Ljv_14
s_waitcnt vmcnt(5)
s_branch Ljv_15
Ljv_14:
s_waitcnt vmcnt(0)
Ljv_15:
s_barrier
v_and_b32 v35, 63, v0
v_lshlrev_b32 v35, 4, v35
s_and_b32 s61, s52, 1
s_lshl_b32 s61, s61, 12
s_add_u32 s61, s61, 84992
s_sub_u32 s61, s61, s53
v_add_u32 v36, s61, v6
ds_read_b128 v[176:179], v36
v_add_u32 v36, s61, v7
ds_read_b128 v[180:183], v36
v_add_u32 v36, s61, v8
ds_read_b128 v[184:187], v36
v_add_u32 v36, s61, v9
ds_read_b128 v[188:191], v36
s_lshr_b32 s61, s52, 1
s_lshl_b32 s61, s61, 14
s_add_u32 s61, s61, 99840
v_add_u32 v36, s61, v35
ds_read_b128 v[160:163], v36 offset:0
ds_read_b128 v[164:167], v36 offset:1024
ds_read_b128 v[168:171], v36 offset:2048
ds_read_b128 v[172:175], v36 offset:3072
v_lshrrev_b32 v36, 3, v0
v_bfe_u32 v1, v0, 4, 3
v_and_b32 v2, 7, v0
v_xor_b32 v1, v1, v2
v_lshlrev_b32 v1, 4, v1
v_lshl_add_u32 v1, v36, 7, v1
v_add_u32 v1, 84992, v1
ds_read_b128 v[60:63], v1
v_add_u32 v35, 66560, v35
ds_read_b128 v[76:79], v35 offset:0
ds_read_b128 v[80:83], v35 offset:1024
ds_read_b128 v[84:87], v35 offset:2048
ds_read_b128 v[88:91], v35 offset:3072
ds_read_b128 v[92:95], v35 offset:4096
ds_read_b128 v[96:99], v35 offset:5120
ds_read_b128 v[100:103], v35 offset:6144
ds_read_b128 v[104:107], v35 offset:7168
ds_read_b128 v[108:111], v35 offset:8192
ds_read_b128 v[112:115], v35 offset:9216
ds_read_b128 v[116:119], v35 offset:10240
ds_read_b128 v[120:123], v35 offset:11264
ds_read_b128 v[124:127], v35 offset:12288
ds_read_b128 v[128:131], v35 offset:13312
ds_read_b128 v[132:135], v35 offset:14336
ds_read_b128 v[136:139], v35 offset:15360
ds_read_b128 v[140:143], v35 offset:16384
ds_read_b128 v[144:147], v35 offset:17408
s_waitcnt lgkmcnt(0)
v_mfma_f32_32x32x16_bf16 v[224:239], v[176:179], v[160:163], 0
v_mfma_f32_32x32x16_bf16 v[224:239], v[180:183], v[164:167], v[224:239]
v_mfma_f32_32x32x16_bf16 v[224:239], v[184:187], v[168:171], v[224:239]
v_mfma_f32_32x32x16_bf16 v[224:239], v[188:191], v[172:175], v[224:239]
s_and_b32 s60, s52, 1
s_lshl_b32 s60, s60, 14
s_lshr_b32 s61, s52, 2
s_lshl_b32 s61, s61, 8
s_add_u32 s60, s60, s61
s_bfe_u32 s61, s52, 0x10001
s_lshl_b32 s61, s61, 7
s_add_u32 s60, s60, s61
s_add_u32 s60, s60, 45568
v_bfe_u32 v36, v0, 5, 1
v_lshlrev_b32 v36, 11, v36
v_add_u32 v36, v36, v12
v_add_u32 v36, s60, v36
s_nop 3
s_cmp_ge_u32 s52, 4
s_cbranch_scc1 Ljw_12
v_cvt_pk_bf16_f32 v224, v224, 0
v_cvt_pk_bf16_f32 v225, v225, 0
v_cvt_pk_bf16_f32 v226, v226, 0
v_cvt_pk_bf16_f32 v227, v227, 0
v_cvt_pk_bf16_f32 v228, v228, 0
v_cvt_pk_bf16_f32 v229, v229, 0
v_cvt_pk_bf16_f32 v230, v230, 0
v_cvt_pk_bf16_f32 v231, v231, 0
v_cvt_pk_bf16_f32 v232, v232, 0
v_cvt_pk_bf16_f32 v233, v233, 0
v_cvt_pk_bf16_f32 v234, v234, 0
v_cvt_pk_bf16_f32 v235, v235, 0
v_cvt_pk_bf16_f32 v236, v236, 0
v_cvt_pk_bf16_f32 v237, v237, 0
v_cvt_pk_bf16_f32 v238, v238, 0
v_cvt_pk_bf16_f32 v239, v239, 0
Ljw_12:
ds_write_b32 v36, v224 offset:0
ds_write_b32 v36, v225 offset:512
ds_write_b32 v36, v226 offset:1024
ds_write_b32 v36, v227 offset:1536
s_bitcmp1_b32 s52, 0
s_cbranch_scc1 Ljd_13
ds_write_b32 v36, v228 offset:4096
ds_write_b32 v36, v229 offset:4608
ds_write_b32 v36, v230 offset:5120
ds_write_b32 v36, v231 offset:5632
ds_write_b32 v36, v232 offset:8192
ds_write_b32 v36, v233 offset:8704
ds_write_b32 v36, v234 offset:9216
ds_write_b32 v36, v235 offset:9728
ds_write_b32 v36, v236 offset:12288
ds_write_b32 v36, v237 offset:12800
ds_write_b32 v36, v238 offset:13312
ds_write_b32 v36, v239 offset:13824
Ljd_13:
s_waitcnt lgkmcnt(0)
s_barrier
Ljs_11:
s_cmp_eq_u32 s54, 0
s_cbranch_scc1 L_maindone
s_waitcnt lgkmcnt(0)
v_and_or_b32 v56, v56, v24, v3
v_and_or_b32 v57, v57, v24, v4
v_and_or_b32 v58, v58, v24, v3
v_and_or_b32 v59, v59, v24, v4
v_lshrrev_b32 v35, 30, v18
v_add_u32 v18, v18, v11
v_mul_u32_u24 v30, 0x3f80, v35
s_add_u32 m0, s53, 4096
s_nop 0
buffer_load_dwordx4 v56, s[28:31], 0 offen lds
s_add_u32 m0, s53, 5120
s_nop 0
buffer_load_dwordx4 v57, s[28:31], 0 offen lds
s_add_u32 m0, s53, 6144
s_nop 0
buffer_load_dwordx4 v58, s[28:31], 0 offen lds
s_add_u32 m0, s53, 7168
s_nop 0
buffer_load_dwordx4 v59, s[28:31], 0 offen lds
buffer_load_dwordx4 v[152:155], v18, s[32:35], 0 offen
v_and_or_b32 v19, v15, v23, v5
v_and_or_b32 v20, v16, v23, v10
ds_read_b128 v[56:59], v19 offset:2560
ds_read_b32 v18, v20 offset:24064
ds_read_b32 v15, v13 offset:12
ds_read_b32 v16, v14 offset:12
ds_read_b32 v17, v13 offset:4
ds_read_b32 v68, v21 offset:45568
ds_read_b32 v70, v21 offset:45696
v_add_u32 v26, 20480, v37
v_mov_b32 v28, 0
s_mov_b64 s[72:73], 0
v_mov_b32 v65, v29
v_mov_b32 v208, 0
v_mov_b32 v224, 0
v_mov_b32 v209, 0
v_mov_b32 v225, 0
v_mov_b32 v210, 0
v_mov_b32 v226, 0
v_mov_b32 v211, 0
v_mov_b32 v227, 0
v_mov_b32 v212, 0
v_mov_b32 v228, 0
v_mov_b32 v213, 0
v_mov_b32 v229, 0
v_mov_b32 v214, 0
v_mov_b32 v230, 0
v_mov_b32 v215, 0
v_mov_b32 v231, 0
v_mov_b32 v216, 0
v_mov_b32 v232, 0
v_mov_b32 v217, 0
v_mov_b32 v233, 0
v_mov_b32 v218, 0
v_mov_b32 v234, 0
v_mov_b32 v219, 0
v_mov_b32 v235, 0
v_mov_b32 v220, 0
v_mov_b32 v236, 0
v_mov_b32 v221, 0
v_mov_b32 v237, 0
v_mov_b32 v222, 0
v_mov_b32 v238, 0
v_mov_b32 v223, 0
v_mov_b32 v239, 0
s_waitcnt lgkmcnt(0)
v_and_or_b32 v56, v56, v24, v3
v_and_or_b32 v57, v57, v24, v4
v_and_or_b32 v58, v58, v24, v3
v_and_or_b32 v59, v59, v24, v4
s_waitcnt vmcnt(5)
ds_read_b128 v[160:163], v6 offset:0
ds_read_b128 v[164:167], v7 offset:0
ds_read_b128 v[168:171], v8 offset:0
ds_read_b128 v[172:175], v9 offset:0
v_mov_b32 v156, v148
v_mov_b32 v157, v149
v_mov_b32 v158, v150
v_mov_b32 v159, v151
v_lshrrev_b32 v35, 30, v18
v_add_u32 v18, v18, v11
v_mul_u32_u24 v29, 0x3f80, v35
s_waitcnt lgkmcnt(0)
v_mfma_f32_32x32x16_bf16 v[192:207], v[64:67], v[68:71], 0
v_mfma_f32_32x32x16_bf16 v[192:207], v[156:159], v[140:143], v[192:207]
v_mfma_f32_32x32x16_bf16 v[192:207], v[160:163], v[76:79], v[192:207]
v_mfma_f32_32x32x16_bf16 v[192:207], v[164:167], v[80:83], v[192:207]
v_mfma_f32_32x32x16_bf16 v[192:207], v[168:171], v[84:87], v[192:207]
v_mfma_f32_32x32x16_bf16 v[192:207], v[172:175], v[88:91], v[192:207]
s_add_u32 m0, s53, 0
s_nop 0
buffer_load_dwordx4 v56, s[28:31], 0 offen lds
s_add_u32 m0, s53, 1024
s_nop 0
buffer_load_dwordx4 v57, s[28:31], 0 offen lds
s_add_u32 m0, s53, 2048
s_nop 0
buffer_load_dwordx4 v58, s[28:31], 0 offen lds
s_add_u32 m0, s53, 3072
s_nop 0
buffer_load_dwordx4 v59, s[28:31], 0 offen lds
buffer_load_dwordx4 v[148:151], v18, s[32:35], 0 offen
v_exp_f32 v192, v192
v_exp_f32 v193, v193
v_exp_f32 v194, v194
v_exp_f32 v195, v195
v_exp_f32 v196, v196
v_exp_f32 v197, v197
v_exp_f32 v198, v198
v_exp_f32 v199, v199
v_exp_f32 v200, v200
v_exp_f32 v201, v201
v_exp_f32 v202, v202
v_exp_f32 v203, v203
v_exp_f32 v204, v204
v_exp_f32 v205, v205
v_exp_f32 v206, v206
v_exp_f32 v207, v207
L_loop:
s_cmp_eq_u32 s54, 1
s_cbranch_scc1 L_last0
s_setprio 0
s_waitcnt lgkmcnt(0)
v_add_f32 v192, 1.0, v192
v_add_f32 v193, 1.0, v193
v_add_f32 v194, 1.0, v194
v_add_f32 v195, 1.0, v195
v_add_f32 v196, 1.0, v196
v_add_f32 v197, 1.0, v197
v_add_f32 v198, 1.0, v198
v_add_f32 v199, 1.0, v199
v_and_b32 v32, v32, v28
v_and_b32 v34, v34, v28
v_add_f32 v32, v32, v208
v_fma_f32 v34, v208, v224, v34
v_add_f32 v32, v32, v209
v_fma_f32 v34, v209, v225, v34
v_add_f32 v32, v32, v210
v_fma_f32 v34, v210, v226, v34
v_add_f32 v32, v32, v211
v_fma_f32 v34, v211, v227, v34
v_add_f32 v32, v32, v212
v_fma_f32 v34, v212, v228, v34
v_add_f32 v32, v32, v213
v_fma_f32 v34, v213, v229, v34
v_add_f32 v32, v32, v214
v_fma_f32 v34, v214, v230, v34
v_add_f32 v32, v32, v215
v_fma_f32 v34, v215, v231, v34
v_add_f32 v32, v32, v216
v_fma_f32 v34, v216, v232, v34
v_add_f32 v32, v32, v217
v_fma_f32 v34, v217, v233, v34
v_add_f32 v32, v32, v218
v_fma_f32 v34, v218, v234, v34
v_add_f32 v32, v32, v219
v_fma_f32 v34, v219, v235, v34
v_add_f32 v32, v32, v220
v_fma_f32 v34, v220, v236, v34
v_add_f32 v32, v32, v221
v_fma_f32 v34, v221, v237, v34
v_add_f32 v32, v32, v222
v_fma_f32 v34, v222, v238, v34
v_add_f32 v32, v32, v223
v_fma_f32 v34, v223, v239, v34
v_add_f32 v200, 1.0, v200
v_add_f32 v201, 1.0, v201
v_add_f32 v202, 1.0, v202
v_add_f32 v203, 1.0, v203
v_add_f32 v204, 1.0, v204
v_add_f32 v205, 1.0, v205
v_add_f32 v206, 1.0, v206
v_add_f32 v207, 1.0, v207
v_and_or_b32 v21, v17, v22, v12
v_and_or_b32 v19, v15, v23, v5
v_and_or_b32 v20, v16, v23, v10
s_setprio 2
v_mfma_f32_32x32x16_bf16 v[208:223], v[64:67], v[70:73], 0
v_rcp_f32 v192, v192
v_rcp_f32 v193, v193
v_rcp_f32 v194, v194
v_mfma_f32_32x32x16_bf16 v[208:223], v[156:159], v[144:147], v[208:223]
v_rcp_f32 v195, v195
v_rcp_f32 v196, v196
v_rcp_f32 v197, v197
v_mfma_f32_32x32x16_bf16 v[208:223], v[160:163], v[92:95], v[208:223]
v_rcp_f32 v198, v198
v_rcp_f32 v199, v199
v_rcp_f32 v200, v200
v_mfma_f32_32x32x16_bf16 v[208:223], v[164:167], v[96:99], v[208:223]
v_rcp_f32 v201, v201
v_rcp_f32 v202, v202
v_rcp_f32 v203, v203
v_mfma_f32_32x32x16_bf16 v[208:223], v[168:171], v[100:103], v[208:223]
v_rcp_f32 v204, v204
v_rcp_f32 v205, v205
v_rcp_f32 v206, v206
v_mfma_f32_32x32x16_bf16 v[208:223], v[172:175], v[104:107], v[208:223]
v_rcp_f32 v207, v207
s_setprio 1
s_waitcnt vmcnt(5)
ds_read_b128 v[176:179], v6 offset:4096
ds_read_b128 v[180:183], v7 offset:4096
ds_read_b128 v[184:187], v8 offset:4096
ds_read_b128 v[188:191], v9 offset:4096
ds_read_b32 v68, v21 offset:45568
ds_read_b32 v70, v21 offset:45696
ds_read_b128 v[56:59], v19 offset:2560
s_mov_b64 exec, s[72:73]
ds_write2_b32 v26, v32, v34 offset0:64 offset1:96
s_mov_b64 exec, -1
ds_read_b32 v18, v20 offset:24064
v_mfma_f32_32x32x16_bf16 v[224:239], v[160:163], v[108:111], 0
v_exp_f32 v208, v208
v_exp_f32 v209, v209
v_exp_f32 v210, v210
v_mfma_f32_32x32x16_bf16 v[224:239], v[164:167], v[112:115], v[224:239]
v_exp_f32 v211, v211
v_exp_f32 v212, v212
v_exp_f32 v213, v213
v_mfma_f32_32x32x16_bf16 v[224:239], v[168:171], v[116:119], v[224:239]
v_exp_f32 v214, v214
v_exp_f32 v215, v215
v_exp_f32 v216, v216
v_mfma_f32_32x32x16_bf16 v[224:239], v[172:175], v[120:123], v[224:239]
v_exp_f32 v217, v217
v_exp_f32 v218, v218
v_exp_f32 v219, v219
v_exp_f32 v220, v220
v_exp_f32 v221, v221
v_exp_f32 v222, v222
v_exp_f32 v223, v223
s_setprio 0
s_waitcnt lgkmcnt(0)
v_add_f32 v208, 1.0, v208
v_add_f32 v209, 1.0, v209
v_add_f32 v210, 1.0, v210
v_add_f32 v211, 1.0, v211
v_add_f32 v212, 1.0, v212
v_add_f32 v213, 1.0, v213
v_add_f32 v214, 1.0, v214
v_add_f32 v215, 1.0, v215
v_mov_b32 v156, v152
v_mov_b32 v157, v153
v_mov_b32 v158, v154
v_mov_b32 v159, v155
v_mov_b32 v65, v30
v_and_b32 v31, v31, v27
v_and_b32 v33, v33, v27
v_add_f32 v31, v31, v192
v_fma_f32 v33, v192, v224, v33
v_add_f32 v31, v31, v193
v_fma_f32 v33, v193, v225, v33
v_add_f32 v31, v31, v194
v_fma_f32 v33, v194, v226, v33
v_add_f32 v31, v31, v195
v_fma_f32 v33, v195, v227, v33
v_add_f32 v31, v31, v196
v_fma_f32 v33, v196, v228, v33
v_add_f32 v31, v31, v197
v_fma_f32 v33, v197, v229, v33
v_add_f32 v31, v31, v198
v_fma_f32 v33, v198, v230, v33
v_add_f32 v31, v31, v199
v_fma_f32 v33, v199, v231, v33
v_add_f32 v31, v31, v200
v_fma_f32 v33, v200, v232, v33
v_add_f32 v31, v31, v201
v_fma_f32 v33, v201, v233, v33
v_add_f32 v31, v31, v202
v_fma_f32 v33, v202, v234, v33
v_add_f32 v31, v31, v203
v_fma_f32 v33, v203, v235, v33
v_add_f32 v31, v31, v204
v_fma_f32 v33, v204, v236, v33
v_add_f32 v31, v31, v205
v_fma_f32 v33, v205, v237, v33
v_add_f32 v31, v31, v206
v_fma_f32 v33, v206, v238, v33
v_add_f32 v31, v31, v207
v_fma_f32 v33, v207, v239, v33
v_add_f32 v216, 1.0, v216
v_add_f32 v217, 1.0, v217
v_add_f32 v218, 1.0, v218
v_add_f32 v219, 1.0, v219
v_add_f32 v220, 1.0, v220
v_add_f32 v221, 1.0, v221
v_add_f32 v222, 1.0, v222
v_add_f32 v223, 1.0, v223
v_add_u32_sdwa v26, v17, v37 dst_sel:DWORD dst_unused:UNUSED_PAD src0_sel:WORD_1 src1_sel:DWORD
v_bfe_i32 v28, v17, 0, 1
v_and_or_b32 v56, v56, v24, v3
v_and_or_b32 v57, v57, v24, v4
v_and_or_b32 v58, v58, v24, v3
v_and_or_b32 v59, v59, v24, v4
v_cmp_eq_u32 s[70:71], 0, v28
v_lshrrev_b32 v35, 30, v18
v_add_u32 v18, v18, v11
v_mul_u32_u24 v30, 0x3f80, v35
s_setprio 2
v_mfma_f32_32x32x16_bf16 v[192:207], v[64:67], v[68:71], 0
v_rcp_f32 v208, v208
v_rcp_f32 v209, v209
v_rcp_f32 v210, v210
v_mfma_f32_32x32x16_bf16 v[192:207], v[156:159], v[140:143], v[192:207]
v_rcp_f32 v211, v211
v_rcp_f32 v212, v212
v_rcp_f32 v213, v213
v_mfma_f32_32x32x16_bf16 v[192:207], v[176:179], v[76:79], v[192:207]
v_rcp_f32 v214, v214
v_rcp_f32 v215, v215
v_rcp_f32 v216, v216
v_mfma_f32_32x32x16_bf16 v[192:207], v[180:183], v[80:83], v[192:207]
v_rcp_f32 v217, v217
v_rcp_f32 v218, v218
v_rcp_f32 v219, v219
v_mfma_f32_32x32x16_bf16 v[192:207], v[184:187], v[84:87], v[192:207]
v_rcp_f32 v220, v220
v_rcp_f32 v221, v221
v_rcp_f32 v222, v222
v_mfma_f32_32x32x16_bf16 v[192:207], v[188:191], v[88:91], v[192:207]
v_rcp_f32 v223, v223
s_setprio 1
buffer_load_dwordx4 v[152:155], v18, s[32:35], 0 offen
s_add_u32 m0, s53, 4096
ds_read_b32 v15, v13 offset:16
buffer_load_dwordx4 v56, s[28:31], 0 offen lds
s_add_u32 m0, s53, 5120
ds_read_b32 v16, v14 offset:16
buffer_load_dwordx4 v57, s[28:31], 0 offen lds
s_add_u32 m0, s53, 6144
ds_read_b32 v17, v13 offset:8
buffer_load_dwordx4 v58, s[28:31], 0 offen lds
s_add_u32 m0, s53, 7168
s_nop 0
buffer_load_dwordx4 v59, s[28:31], 0 offen lds
s_mov_b64 exec, s[70:71]
ds_write2_b32 v25, v31, v33 offset0:0 offset1:32
s_mov_b64 exec, -1
s_nop 0
v_mfma_f32_32x32x16_bf16 v[224:239], v[160:163], v[124:127], 0
v_exp_f32 v192, v192
v_exp_f32 v193, v193
v_exp_f32 v194, v194
v_mfma_f32_32x32x16_bf16 v[224:239], v[164:167], v[128:131], v[224:239]
v_exp_f32 v195, v195
v_exp_f32 v196, v196
v_exp_f32 v197, v197
v_mfma_f32_32x32x16_bf16 v[224:239], v[168:171], v[132:135], v[224:239]
v_exp_f32 v198, v198
v_exp_f32 v199, v199
v_exp_f32 v200, v200
v_mfma_f32_32x32x16_bf16 v[224:239], v[172:175], v[136:139], v[224:239]
v_exp_f32 v201, v201
v_exp_f32 v202, v202
v_exp_f32 v203, v203
v_exp_f32 v204, v204
v_exp_f32 v205, v205
v_exp_f32 v206, v206
v_exp_f32 v207, v207
s_sub_u32 s54, s54, 1
s_cmp_eq_u32 s54, 1
s_cbranch_scc1 L_last1
s_setprio 0
s_waitcnt lgkmcnt(0)
v_add_f32 v192, 1.0, v192
v_add_f32 v193, 1.0, v193
v_add_f32 v194, 1.0, v194
v_add_f32 v195, 1.0, v195
v_add_f32 v196, 1.0, v196
v_add_f32 v197, 1.0, v197
v_add_f32 v198, 1.0, v198
v_add_f32 v199, 1.0, v199
v_and_b32 v32, v32, v27
v_and_b32 v34, v34, v27
v_add_f32 v32, v32, v208
v_fma_f32 v34, v208, v224, v34
v_add_f32 v32, v32, v209
v_fma_f32 v34, v209, v225, v34
v_add_f32 v32, v32, v210
v_fma_f32 v34, v210, v226, v34
v_add_f32 v32, v32, v211
v_fma_f32 v34, v211, v227, v34
v_add_f32 v32, v32, v212
v_fma_f32 v34, v212, v228, v34
v_add_f32 v32, v32, v213
v_fma_f32 v34, v213, v229, v34
v_add_f32 v32, v32, v214
v_fma_f32 v34, v214, v230, v34
v_add_f32 v32, v32, v215
v_fma_f32 v34, v215, v231, v34
v_add_f32 v32, v32, v216
v_fma_f32 v34, v216, v232, v34
v_add_f32 v32, v32, v217
v_fma_f32 v34, v217, v233, v34
v_add_f32 v32, v32, v218
v_fma_f32 v34, v218, v234, v34
v_add_f32 v32, v32, v219
v_fma_f32 v34, v219, v235, v34
v_add_f32 v32, v32, v220
v_fma_f32 v34, v220, v236, v34
v_add_f32 v32, v32, v221
v_fma_f32 v34, v221, v237, v34
v_add_f32 v32, v32, v222
v_fma_f32 v34, v222, v238, v34
v_add_f32 v32, v32, v223
v_fma_f32 v34, v223, v239, v34
v_add_f32 v200, 1.0, v200
v_add_f32 v201, 1.0, v201
v_add_f32 v202, 1.0, v202
v_add_f32 v203, 1.0, v203
v_add_f32 v204, 1.0, v204
v_add_f32 v205, 1.0, v205
v_add_f32 v206, 1.0, v206
v_add_f32 v207, 1.0, v207
v_and_or_b32 v21, v17, v22, v12
v_and_or_b32 v19, v15, v23, v5
v_and_or_b32 v20, v16, v23, v10
s_setprio 2
v_mfma_f32_32x32x16_bf16 v[208:223], v[64:67], v[70:73], 0
v_rcp_f32 v192, v192
v_rcp_f32 v193, v193
v_rcp_f32 v194, v194
v_mfma_f32_32x32x16_bf16 v[208:223], v[156:159], v[144:147], v[208:223]
v_rcp_f32 v195, v195
v_rcp_f32 v196, v196
v_rcp_f32 v197, v197
v_mfma_f32_32x32x16_bf16 v[208:223], v[176:179], v[92:95], v[208:223]
v_rcp_f32 v198, v198
v_rcp_f32 v199, v199
v_rcp_f32 v200, v200
v_mfma_f32_32x32x16_bf16 v[208:223], v[180:183], v[96:99], v[208:223]
v_rcp_f32 v201, v201
v_rcp_f32 v202, v202
v_rcp_f32 v203, v203
v_mfma_f32_32x32x16_bf16 v[208:223], v[184:187], v[100:103], v[208:223]
v_rcp_f32 v204, v204
v_rcp_f32 v205, v205
v_rcp_f32 v206, v206
v_mfma_f32_32x32x16_bf16 v[208:223], v[188:191], v[104:107], v[208:223]
v_rcp_f32 v207, v207
s_setprio 1
s_waitcnt vmcnt(5)
ds_read_b128 v[160:163], v6 offset:0
ds_read_b128 v[164:167], v7 offset:0
ds_read_b128 v[168:171], v8 offset:0
ds_read_b128 v[172:175], v9 offset:0
ds_read_b32 v68, v21 offset:45568
ds_read_b32 v70, v21 offset:45696
ds_read_b128 v[56:59], v19 offset:2560
s_mov_b64 exec, s[70:71]
ds_write2_b32 v25, v32, v34 offset0:64 offset1:96
s_mov_b64 exec, -1
ds_read_b32 v18, v20 offset:24064
v_mfma_f32_32x32x16_bf16 v[224:239], v[176:179], v[108:111], 0
v_exp_f32 v208, v208
v_exp_f32 v209, v209
v_exp_f32 v210, v210
v_mfma_f32_32x32x16_bf16 v[224:239], v[180:183], v[112:115], v[224:239]
v_exp_f32 v211, v211
v_exp_f32 v212, v212
v_exp_f32 v213, v213
v_mfma_f32_32x32x16_bf16 v[224:239], v[184:187], v[116:119], v[224:239]
v_exp_f32 v214, v214
v_exp_f32 v215, v215
v_exp_f32 v216, v216
v_mfma_f32_32x32x16_bf16 v[224:239], v[188:191], v[120:123], v[224:239]
v_exp_f32 v217, v217
v_exp_f32 v218, v218
v_exp_f32 v219, v219
v_exp_f32 v220, v220
v_exp_f32 v221, v221
v_exp_f32 v222, v222
v_exp_f32 v223, v223
s_setprio 0
s_waitcnt lgkmcnt(0)
v_add_f32 v208, 1.0, v208
v_add_f32 v209, 1.0, v209
v_add_f32 v210, 1.0, v210
v_add_f32 v211, 1.0, v211
v_add_f32 v212, 1.0, v212
v_add_f32 v213, 1.0, v213
v_add_f32 v214, 1.0, v214
v_add_f32 v215, 1.0, v215
v_mov_b32 v156, v148
v_mov_b32 v157, v149
v_mov_b32 v158, v150
v_mov_b32 v159, v151
v_mov_b32 v65, v29
v_and_b32 v31, v31, v28
v_and_b32 v33, v33, v28
v_add_f32 v31, v31, v192
v_fma_f32 v33, v192, v224, v33
v_add_f32 v31, v31, v193
v_fma_f32 v33, v193, v225, v33
v_add_f32 v31, v31, v194
v_fma_f32 v33, v194, v226, v33
v_add_f32 v31, v31, v195
v_fma_f32 v33, v195, v227, v33
v_add_f32 v31, v31, v196
v_fma_f32 v33, v196, v228, v33
v_add_f32 v31, v31, v197
v_fma_f32 v33, v197, v229, v33
v_add_f32 v31, v31, v198
v_fma_f32 v33, v198, v230, v33
v_add_f32 v31, v31, v199
v_fma_f32 v33, v199, v231, v33
v_add_f32 v31, v31, v200
v_fma_f32 v33, v200, v232, v33
v_add_f32 v31, v31, v201
v_fma_f32 v33, v201, v233, v33
v_add_f32 v31, v31, v202
v_fma_f32 v33, v202, v234, v33
v_add_f32 v31, v31, v203
v_fma_f32 v33, v203, v235, v33
v_add_f32 v31, v31, v204
v_fma_f32 v33, v204, v236, v33
v_add_f32 v31, v31, v205
v_fma_f32 v33, v205, v237, v33
v_add_f32 v31, v31, v206
v_fma_f32 v33, v206, v238, v33
v_add_f32 v31, v31, v207
v_fma_f32 v33, v207, v239, v33
v_add_f32 v216, 1.0, v216
v_add_f32 v217, 1.0, v217
v_add_f32 v218, 1.0, v218
v_add_f32 v219, 1.0, v219
v_add_f32 v220, 1.0, v220
v_add_f32 v221, 1.0, v221
v_add_f32 v222, 1.0, v222
v_add_f32 v223, 1.0, v223
v_add_u32_sdwa v25, v17, v37 dst_sel:DWORD dst_unused:UNUSED_PAD src0_sel:WORD_1 src1_sel:DWORD
v_bfe_i32 v27, v17, 0, 1
v_and_or_b32 v56, v56, v24, v3
v_and_or_b32 v57, v57, v24, v4
v_and_or_b32 v58, v58, v24, v3
v_and_or_b32 v59, v59, v24, v4
v_cmp_eq_u32 s[72:73], 0, v27
v_lshrrev_b32 v35, 30, v18
v_add_u32 v18, v18, v11
v_mul_u32_u24 v29, 0x3f80, v35
v_add_u32 v13, 8, v13
v_add_u32 v14, 8, v14
s_setprio 2
v_mfma_f32_32x32x16_bf16 v[192:207], v[64:67], v[68:71], 0
v_rcp_f32 v208, v208
v_rcp_f32 v209, v209
v_rcp_f32 v210, v210
v_mfma_f32_32x32x16_bf16 v[192:207], v[156:159], v[140:143], v[192:207]
v_rcp_f32 v211, v211
v_rcp_f32 v212, v212
v_rcp_f32 v213, v213
v_mfma_f32_32x32x16_bf16 v[192:207], v[160:163], v[76:79], v[192:207]
v_rcp_f32 v214, v214
v_rcp_f32 v215, v215
v_rcp_f32 v216, v216
v_mfma_f32_32x32x16_bf16 v[192:207], v[164:167], v[80:83], v[192:207]
v_rcp_f32 v217, v217
v_rcp_f32 v218, v218
v_rcp_f32 v219, v219
v_mfma_f32_32x32x16_bf16 v[192:207], v[168:171], v[84:87], v[192:207]
v_rcp_f32 v220, v220
v_rcp_f32 v221, v221
v_rcp_f32 v222, v222
v_mfma_f32_32x32x16_bf16 v[192:207], v[172:175], v[88:91], v[192:207]
v_rcp_f32 v223, v223
s_setprio 1
buffer_load_dwordx4 v[148:151], v18, s[32:35], 0 offen
s_add_u32 m0, s53, 0
ds_read_b32 v15, v13 offset:12
buffer_load_dwordx4 v56, s[28:31], 0 offen lds
s_add_u32 m0, s53, 1024
ds_read_b32 v16, v14 offset:12
buffer_load_dwordx4 v57, s[28:31], 0 offen lds
s_add_u32 m0, s53, 2048
ds_read_b32 v17, v13 offset:4
buffer_load_dwordx4 v58, s[28:31], 0 offen lds
s_add_u32 m0, s53, 3072
s_nop 0
buffer_load_dwordx4 v59, s[28:31], 0 offen lds
s_mov_b64 exec, s[72:73]
ds_write2_b32 v26, v31, v33 offset0:0 offset1:32
s_mov_b64 exec, -1
s_nop 0
v_mfma_f32_32x32x16_bf16 v[224:239], v[176:179], v[124:127], 0
v_exp_f32 v192, v192
v_exp_f32 v193, v193
v_exp_f32 v194, v194
v_mfma_f32_32x32x16_bf16 v[224:239], v[180:183], v[128:131], v[224:239]
v_exp_f32 v195, v195
v_exp_f32 v196, v196
v_exp_f32 v197, v197
v_mfma_f32_32x32x16_bf16 v[224:239], v[184:187], v[132:135], v[224:239]
v_exp_f32 v198, v198
v_exp_f32 v199, v199
v_exp_f32 v200, v200
v_mfma_f32_32x32x16_bf16 v[224:239], v[188:191], v[136:139], v[224:239]
v_exp_f32 v201, v201
v_exp_f32 v202, v202
v_exp_f32 v203, v203
v_exp_f32 v204, v204
v_exp_f32 v205, v205
v_exp_f32 v206, v206
v_exp_f32 v207, v207
s_sub_u32 s54, s54, 1
s_branch L_loop
L_last1:
s_setprio 0
s_waitcnt lgkmcnt(0)
v_add_f32 v192, 1.0, v192
v_add_f32 v193, 1.0, v193
v_add_f32 v194, 1.0, v194
v_add_f32 v195, 1.0, v195
v_add_f32 v196, 1.0, v196
v_add_f32 v197, 1.0, v197
v_add_f32 v198, 1.0, v198
v_add_f32 v199, 1.0, v199
v_and_b32 v32, v32, v27
v_and_b32 v34, v34, v27
v_add_f32 v32, v32, v208
v_fma_f32 v34, v208, v224, v34
v_add_f32 v32, v32, v209
v_fma_f32 v34, v209, v225, v34
v_add_f32 v32, v32, v210
v_fma_f32 v34, v210, v226, v34
v_add_f32 v32, v32, v211
v_fma_f32 v34, v211, v227, v34
v_add_f32 v32, v32, v212
v_fma_f32 v34, v212, v228, v34
v_add_f32 v32, v32, v213
v_fma_f32 v34, v213, v229, v34
v_add_f32 v32, v32, v214
v_fma_f32 v34, v214, v230, v34
v_add_f32 v32, v32, v215
v_fma_f32 v34, v215, v231, v34
v_add_f32 v32, v32, v216
v_fma_f32 v34, v216, v232, v34
v_add_f32 v32, v32, v217
v_fma_f32 v34, v217, v233, v34
v_add_f32 v32, v32, v218
v_fma_f32 v34, v218, v234, v34
v_add_f32 v32, v32, v219
v_fma_f32 v34, v219, v235, v34
v_add_f32 v32, v32, v220
v_fma_f32 v34, v220, v236, v34
v_add_f32 v32, v32, v221
v_fma_f32 v34, v221, v237, v34
v_add_f32 v32, v32, v222
v_fma_f32 v34, v222, v238, v34
v_add_f32 v32, v32, v223
v_fma_f32 v34, v223, v239, v34
v_add_f32 v200, 1.0, v200
v_add_f32 v201, 1.0, v201
v_add_f32 v202, 1.0, v202
v_add_f32 v203, 1.0, v203
v_add_f32 v204, 1.0, v204
v_add_f32 v205, 1.0, v205
v_add_f32 v206, 1.0, v206
v_add_f32 v207, 1.0, v207
s_setprio 2
v_mfma_f32_32x32x16_bf16 v[208:223], v[64:67], v[70:73], 0
v_rcp_f32 v192, v192
v_rcp_f32 v193, v193
v_rcp_f32 v194, v194
v_mfma_f32_32x32x16_bf16 v[208:223], v[156:159], v[144:147], v[208:223]
v_rcp_f32 v195, v195
v_rcp_f32 v196, v196
v_rcp_f32 v197, v197
v_mfma_f32_32x32x16_bf16 v[208:223], v[176:179], v[92:95], v[208:223]
v_rcp_f32 v198, v198
v_rcp_f32 v199, v199
v_rcp_f32 v200, v200
v_mfma_f32_32x32x16_bf16 v[208:223], v[180:183], v[96:99], v[208:223]
v_rcp_f32 v201, v201
v_rcp_f32 v202, v202
v_rcp_f32 v203, v203
v_mfma_f32_32x32x16_bf16 v[208:223], v[184:187], v[100:103], v[208:223]
v_rcp_f32 v204, v204
v_rcp_f32 v205, v205
v_rcp_f32 v206, v206
v_mfma_f32_32x32x16_bf16 v[208:223], v[188:191], v[104:107], v[208:223]
v_rcp_f32 v207, v207
s_setprio 1
s_mov_b64 exec, s[70:71]
ds_write2_b32 v25, v32, v34 offset0:64 offset1:96
s_mov_b64 exec, -1
s_nop 7
v_mfma_f32_32x32x16_bf16 v[224:239], v[176:179], v[108:111], 0
v_exp_f32 v208, v208
v_exp_f32 v209, v209
v_exp_f32 v210, v210
v_mfma_f32_32x32x16_bf16 v[224:239], v[180:183], v[112:115], v[224:239]
v_exp_f32 v211, v211
v_exp_f32 v212, v212
v_exp_f32 v213, v213
v_mfma_f32_32x32x16_bf16 v[224:239], v[184:187], v[116:119], v[224:239]
v_exp_f32 v214, v214
v_exp_f32 v215, v215
v_exp_f32 v216, v216
v_mfma_f32_32x32x16_bf16 v[224:239], v[188:191], v[120:123], v[224:239]
v_exp_f32 v217, v217
v_exp_f32 v218, v218
v_exp_f32 v219, v219
v_exp_f32 v220, v220
v_exp_f32 v221, v221
v_exp_f32 v222, v222
v_exp_f32 v223, v223
s_setprio 0
s_waitcnt lgkmcnt(0)
v_add_f32 v208, 1.0, v208
v_add_f32 v209, 1.0, v209
v_add_f32 v210, 1.0, v210
v_add_f32 v211, 1.0, v211
v_add_f32 v212, 1.0, v212
v_add_f32 v213, 1.0, v213
v_add_f32 v214, 1.0, v214
v_add_f32 v215, 1.0, v215
v_and_b32 v31, v31, v28
v_and_b32 v33, v33, v28
v_add_f32 v31, v31, v192
v_fma_f32 v33, v192, v224, v33
v_add_f32 v31, v31, v193
v_fma_f32 v33, v193, v225, v33
v_add_f32 v31, v31, v194
v_fma_f32 v33, v194, v226, v33
v_add_f32 v31, v31, v195
v_fma_f32 v33, v195, v227, v33
v_add_f32 v31, v31, v196
v_fma_f32 v33, v196, v228, v33
v_add_f32 v31, v31, v197
v_fma_f32 v33, v197, v229, v33
v_add_f32 v31, v31, v198
v_fma_f32 v33, v198, v230, v33
v_add_f32 v31, v31, v199
v_fma_f32 v33, v199, v231, v33
v_add_f32 v31, v31, v200
v_fma_f32 v33, v200, v232, v33
v_add_f32 v31, v31, v201
v_fma_f32 v33, v201, v233, v33
v_add_f32 v31, v31, v202
v_fma_f32 v33, v202, v234, v33
v_add_f32 v31, v31, v203
v_fma_f32 v33, v203, v235, v33
v_add_f32 v31, v31, v204
v_fma_f32 v33, v204, v236, v33
v_add_f32 v31, v31, v205
v_fma_f32 v33, v205, v237, v33
v_add_f32 v31, v31, v206
v_fma_f32 v33, v206, v238, v33
v_add_f32 v31, v31, v207
v_fma_f32 v33, v207, v239, v33
v_add_f32 v216, 1.0, v216
v_add_f32 v217, 1.0, v217
v_add_f32 v218, 1.0, v218
v_add_f32 v219, 1.0, v219
v_add_f32 v220, 1.0, v220
v_add_f32 v221, 1.0, v221
v_add_f32 v222, 1.0, v222
v_add_f32 v223, 1.0, v223
s_setprio 2
v_mfma_f32_32x32x16_bf16 v[224:239], v[176:179], v[124:127], 0
v_rcp_f32 v208, v208
v_rcp_f32 v209, v209
v_rcp_f32 v210, v210
v_mfma_f32_32x32x16_bf16 v[224:239], v[180:183], v[128:131], v[224:239]
v_rcp_f32 v211, v211
v_rcp_f32 v212, v212
v_rcp_f32 v213, v213
v_mfma_f32_32x32x16_bf16 v[224:239], v[184:187], v[132:135], v[224:239]
v_rcp_f32 v214, v214
v_rcp_f32 v215, v215
v_rcp_f32 v216, v216
v_mfma_f32_32x32x16_bf16 v[224:239], v[188:191], v[136:139], v[224:239]
v_rcp_f32 v217, v217
v_rcp_f32 v218, v218
v_rcp_f32 v219, v219
v_rcp_f32 v220, v220
v_rcp_f32 v221, v221
v_rcp_f32 v222, v222
v_rcp_f32 v223, v223
s_setprio 0
ds_write2_b32 v26, v31, v33 offset0:0 offset1:32
v_and_b32 v32, v32, v28
v_and_b32 v34, v34, v28
v_add_f32 v32, v32, v208
v_add_f32 v32, v32, v209
v_add_f32 v32, v32, v210
v_add_f32 v32, v32, v211
v_add_f32 v32, v32, v212
v_add_f32 v32, v32, v213
v_add_f32 v32, v32, v214
v_add_f32 v32, v32, v215
v_add_f32 v32, v32, v216
v_add_f32 v32, v32, v217
v_add_f32 v32, v32, v218
v_add_f32 v32, v32, v219
v_add_f32 v32, v32, v220
v_add_f32 v32, v32, v221
v_add_f32 v32, v32, v222
v_add_f32 v32, v32, v223
v_fma_f32 v34, v208, v224, v34
v_fma_f32 v34, v209, v225, v34
v_fma_f32 v34, v210, v226, v34
v_fma_f32 v34, v211, v227, v34
v_fma_f32 v34, v212, v228, v34
v_fma_f32 v34, v213, v229, v34
v_fma_f32 v34, v214, v230, v34
v_fma_f32 v34, v215, v231, v34
v_fma_f32 v34, v216, v232, v34
v_fma_f32 v34, v217, v233, v34
v_fma_f32 v34, v218, v234, v34
v_fma_f32 v34, v219, v235, v34
v_fma_f32 v34, v220, v236, v34
v_fma_f32 v34, v221, v237, v34
v_fma_f32 v34, v222, v238, v34
v_fma_f32 v34, v223, v239, v34
ds_write2_b32 v26, v32, v34 offset0:64 offset1:96
s_branch L_maindone
L_last0:
s_setprio 0
s_waitcnt lgkmcnt(0)
v_add_f32 v192, 1.0, v192
v_add_f32 v193, 1.0, v193
v_add_f32 v194, 1.0, v194
v_add_f32 v195, 1.0, v195
v_add_f32 v196, 1.0, v196
v_add_f32 v197, 1.0, v197
v_add_f32 v198, 1.0, v198
v_add_f32 v199, 1.0, v199
v_and_b32 v32, v32, v28
v_and_b32 v34, v34, v28
v_add_f32 v32, v32, v208
v_fma_f32 v34, v208, v224, v34
v_add_f32 v32, v32, v209
v_fma_f32 v34, v209, v225, v34
v_add_f32 v32, v32, v210
v_fma_f32 v34, v210, v226, v34
v_add_f32 v32, v32, v211
v_fma_f32 v34, v211, v227, v34
v_add_f32 v32, v32, v212
v_fma_f32 v34, v212, v228, v34
v_add_f32 v32, v32, v213
v_fma_f32 v34, v213, v229, v34
v_add_f32 v32, v32, v214
v_fma_f32 v34, v214, v230, v34
v_add_f32 v32, v32, v215
v_fma_f32 v34, v215, v231, v34
v_add_f32 v32, v32, v216
v_fma_f32 v34, v216, v232, v34
v_add_f32 v32, v32, v217
v_fma_f32 v34, v217, v233, v34
v_add_f32 v32, v32, v218
v_fma_f32 v34, v218, v234, v34
v_add_f32 v32, v32, v219
v_fma_f32 v34, v219, v235, v34
v_add_f32 v32, v32, v220
v_fma_f32 v34, v220, v236, v34
v_add_f32 v32, v32, v221
v_fma_f32 v34, v221, v237, v34
v_add_f32 v32, v32, v222
v_fma_f32 v34, v222, v238, v34
v_add_f32 v32, v32, v223
v_fma_f32 v34, v223, v239, v34
v_add_f32 v200, 1.0, v200
v_add_f32 v201, 1.0, v201
v_add_f32 v202, 1.0, v202
v_add_f32 v203, 1.0, v203
v_add_f32 v204, 1.0, v204
v_add_f32 v205, 1.0, v205
v_add_f32 v206, 1.0, v206
v_add_f32 v207, 1.0, v207
s_setprio 2
v_mfma_f32_32x32x16_bf16 v[208:223], v[64:67], v[70:73], 0
v_rcp_f32 v192, v192
v_rcp_f32 v193, v193
v_rcp_f32 v194, v194
v_mfma_f32_32x32x16_bf16 v[208:223], v[156:159], v[144:147], v[208:223]
v_rcp_f32 v195, v195
v_rcp_f32 v196, v196
v_rcp_f32 v197, v197
v_mfma_f32_32x32x16_bf16 v[208:223], v[160:163], v[92:95], v[208:223]
v_rcp_f32 v198, v198
v_rcp_f32 v199, v199
v_rcp_f32 v200, v200
v_mfma_f32_32x32x16_bf16 v[208:223], v[164:167], v[96:99], v[208:223]
v_rcp_f32 v201, v201
v_rcp_f32 v202, v202
v_rcp_f32 v203, v203
v_mfma_f32_32x32x16_bf16 v[208:223], v[168:171], v[100:103], v[208:223]
v_rcp_f32 v204, v204
v_rcp_f32 v205, v205
v_rcp_f32 v206, v206
v_mfma_f32_32x32x16_bf16 v[208:223], v[172:175], v[104:107], v[208:223]
v_rcp_f32 v207, v207
s_setprio 1
s_mov_b64 exec, s[72:73]
ds_write2_b32 v26, v32, v34 offset0:64 offset1:96
s_mov_b64 exec, -1
s_nop 7
v_mfma_f32_32x32x16_bf16 v[224:239], v[160:163], v[108:111], 0
v_exp_f32 v208, v208
v_exp_f32 v209, v209
v_exp_f32 v210, v210
v_mfma_f32_32x32x16_bf16 v[224:239], v[164:167], v[112:115], v[224:239]
v_exp_f32 v211, v211
v_exp_f32 v212, v212
v_exp_f32 v213, v213
v_mfma_f32_32x32x16_bf16 v[224:239], v[168:171], v[116:119], v[224:239]
v_exp_f32 v214, v214
v_exp_f32 v215, v215
v_exp_f32 v216, v216
v_mfma_f32_32x32x16_bf16 v[224:239], v[172:175], v[120:123], v[224:239]
v_exp_f32 v217, v217
v_exp_f32 v218, v218
v_exp_f32 v219, v219
v_exp_f32 v220, v220
v_exp_f32 v221, v221
v_exp_f32 v222, v222
v_exp_f32 v223, v223
s_setprio 0
s_waitcnt lgkmcnt(0)
v_add_f32 v208, 1.0, v208
v_add_f32 v209, 1.0, v209
v_add_f32 v210, 1.0, v210
v_add_f32 v211, 1.0, v211
v_add_f32 v212, 1.0, v212
v_add_f32 v213, 1.0, v213
v_add_f32 v214, 1.0, v214
v_add_f32 v215, 1.0, v215
v_and_b32 v31, v31, v27
v_and_b32 v33, v33, v27
v_add_f32 v31, v31, v192
v_fma_f32 v33, v192, v224, v33
v_add_f32 v31, v31, v193
v_fma_f32 v33, v193, v225, v33
v_add_f32 v31, v31, v194
v_fma_f32 v33, v194, v226, v33
v_add_f32 v31, v31, v195
v_fma_f32 v33, v195, v227, v33
v_add_f32 v31, v31, v196
v_fma_f32 v33, v196, v228, v33
v_add_f32 v31, v31, v197
v_fma_f32 v33, v197, v229, v33
v_add_f32 v31, v31, v198
v_fma_f32 v33, v198, v230, v33
v_add_f32 v31, v31, v199
v_fma_f32 v33, v199, v231, v33
v_add_f32 v31, v31, v200
v_fma_f32 v33, v200, v232, v33
v_add_f32 v31, v31, v201
v_fma_f32 v33, v201, v233, v33
v_add_f32 v31, v31, v202
v_fma_f32 v33, v202, v234, v33
v_add_f32 v31, v31, v203
v_fma_f32 v33, v203, v235, v33
v_add_f32 v31, v31, v204
v_fma_f32 v33, v204, v236, v33
v_add_f32 v31, v31, v205
v_fma_f32 v33, v205, v237, v33
v_add_f32 v31, v31, v206
v_fma_f32 v33, v206, v238, v33
v_add_f32 v31, v31, v207
v_fma_f32 v33, v207, v239, v33
v_add_f32 v216, 1.0, v216
v_add_f32 v217, 1.0, v217
v_add_f32 v218, 1.0, v218
v_add_f32 v219, 1.0, v219
v_add_f32 v220, 1.0, v220
v_add_f32 v221, 1.0, v221
v_add_f32 v222, 1.0, v222
v_add_f32 v223, 1.0, v223
s_setprio 2
v_mfma_f32_32x32x16_bf16 v[224:239], v[160:163], v[124:127], 0
v_rcp_f32 v208, v208
v_rcp_f32 v209, v209
v_rcp_f32 v210, v210
v_mfma_f32_32x32x16_bf16 v[224:239], v[164:167], v[128:131], v[224:239]
v_rcp_f32 v211, v211
v_rcp_f32 v212, v212
v_rcp_f32 v213, v213
v_mfma_f32_32x32x16_bf16 v[224:239], v[168:171], v[132:135], v[224:239]
v_rcp_f32 v214, v214
v_rcp_f32 v215, v215
v_rcp_f32 v216, v216
v_mfma_f32_32x32x16_bf16 v[224:239], v[172:175], v[136:139], v[224:239]
v_rcp_f32 v217, v217
v_rcp_f32 v218, v218
v_rcp_f32 v219, v219
v_rcp_f32 v220, v220
v_rcp_f32 v221, v221
v_rcp_f32 v222, v222
v_rcp_f32 v223, v223
s_setprio 0
ds_write2_b32 v25, v31, v33 offset0:0 offset1:32
v_and_b32 v32, v32, v27
v_and_b32 v34, v34, v27
v_add_f32 v32, v32, v208
v_add_f32 v32, v32, v209
v_add_f32 v32, v32, v210
v_add_f32 v32, v32, v211
v_add_f32 v32, v32, v212
v_add_f32 v32, v32, v213
v_add_f32 v32, v32, v214
v_add_f32 v32, v32, v215
v_add_f32 v32, v32, v216
v_add_f32 v32, v32, v217
v_add_f32 v32, v32, v218
v_add_f32 v32, v32, v219
v_add_f32 v32, v32, v220
v_add_f32 v32, v32, v221
v_add_f32 v32, v32, v222
v_add_f32 v32, v32, v223
v_fma_f32 v34, v208, v224, v34
v_fma_f32 v34, v209, v225, v34
v_fma_f32 v34, v210, v226, v34
v_fma_f32 v34, v211, v227, v34
v_fma_f32 v34, v212, v228, v34
v_fma_f32 v34, v213, v229, v34
v_fma_f32 v34, v214, v230, v34
v_fma_f32 v34, v215, v231, v34
v_fma_f32 v34, v216, v232, v34
v_fma_f32 v34, v217, v233, v34
v_fma_f32 v34, v218, v234, v34
v_fma_f32 v34, v219, v235, v34
v_fma_f32 v34, v220, v236, v34
v_fma_f32 v34, v221, v237, v34
v_fma_f32 v34, v222, v238, v34
v_fma_f32 v34, v223, v239, v34
ds_write2_b32 v25, v32, v34 offset0:64 offset1:96
L_maindone:
s_waitcnt vmcnt(0) lgkmcnt(0)
s_barrier
s_cmp_ge_u32 s52, 5
s_cbranch_scc1 Lfold_16
v_lshrrev_b32 v1, 3, v0
v_lshlrev_b32 v36, 2, v1
ds_read_b32 v36, v36 offset:256
v_bfe_u32 v2, v0, 2, 1
v_lshlrev_b32 v2, 8, v2
v_and_b32 v35, 3, v0
v_lshl_or_b32 v2, v35, 5, v2
v_add_u32 v2, 66560, v2
v_lshl_add_u32 v1, v1, 9, v2
s_waitcnt lgkmcnt(0)
v_cmp_lt_u32 vcc, 0xffff, v36
s_and_saveexec_b64 s[62:63], vcc
s_cbranch_execz L_contdone
ds_read_b128 v[192:195], v1
ds_read_b128 v[196:199], v1 offset:16
ds_read_b128 v[200:203], v1 offset:128
ds_read_b128 v[204:207], v1 offset:144
s_waitcnt lgkmcnt(0)
v_add_f32 v40, v40, v192
v_add_f32 v41, v41, v193
v_add_f32 v42, v42, v194
v_add_f32 v43, v43, v195
v_add_f32 v44, v44, v196
v_add_f32 v45, v45, v197
v_add_f32 v46, v46, v198
v_add_f32 v47, v47, v199
v_add_f32 v48, v48, v200
v_add_f32 v49, v49, v201
v_add_f32 v50, v50, v202
v_add_f32 v51, v51, v203
v_add_f32 v52, v52, v204
v_add_f32 v53, v53, v205
v_add_f32 v54, v54, v206
v_add_f32 v55, v55, v207
v_and_b32 v35, 0xff, v36
v_bfe_u32 v36, v36, 8, 8
L_cont:
v_add_u32 v35, 1, v35
v_cmpx_le_u32 vcc, v35, v36
s_cbranch_execz L_contdone
v_add_u32 v1, 41, v35
v_lshl_add_u32 v1, v1, 9, v2
ds_read_b128 v[192:195], v1
ds_read_b128 v[196:199], v1 offset:16
ds_read_b128 v[200:203], v1 offset:128
ds_read_b128 v[204:207], v1 offset:144
s_waitcnt lgkmcnt(0)
v_add_f32 v40, v40, v192
v_add_f32 v41, v41, v193
v_add_f32 v42, v42, v194
v_add_f32 v43, v43, v195
v_add_f32 v44, v44, v196
v_add_f32 v45, v45, v197
v_add_f32 v46, v46, v198
v_add_f32 v47, v47, v199
v_add_f32 v48, v48, v200
v_add_f32 v49, v49, v201
v_add_f32 v50, v50, v202
v_add_f32 v51, v51, v203
v_add_f32 v52, v52, v204
v_add_f32 v53, v53, v205
v_add_f32 v54, v54, v206
v_add_f32 v55, v55, v207
s_branch L_cont
L_contdone:
s_mov_b64 exec, -1
Lfold_16:
s_cmp_eq_u32 s55, 0
s_cbranch_scc1 L_epi
s_add_u32 s56, s56, 1
s_cmp_ge_u32 s56, 5000
s_cbranch_scc1 L_epi
L_slowfill:
s_waitcnt lgkmcnt(0)
s_barrier
v_lshlrev_b32 v1, 4, v0
s_cmp_gt_u32 s52, 2
s_cbranch_scc1 Li_17
v_mov_b32 v56, 0x50005000
v_cmp_gt_u32 vcc, 32, v0
s_nop 1
v_cndmask_b32_e64 v56, v56, 0, vcc
v_mov_b32 v57, v56
v_mov_b32 v58, v56
v_mov_b32 v59, v56
v_cmp_gt_u32 vcc, 160, v0
s_and_saveexec_b64 s[62:63], vcc
ds_write_b128 v1, v[56:59] offset:0
s_mov_b64 exec, s[62:63]
Li_17:
s_waitcnt lgkmcnt(0)
s_barrier
s_cmp_gt_u32 s52, 1
s_cbranch_scc1 Lsf_18
s_mov_b32 s44, s8
s_and_b32 s45, s9, 0xffff
s_mov_b32 s46, 2560000
s_mov_b32 s47, 0x20000
s_mov_b32 s48, s10
s_and_b32 s49, s11, 0xffff
s_mov_b32 s50, 2560000
s_mov_b32 s51, 0x20000
s_lshl_b32 s60, s56, 7
v_add_u32 v15, s60, v0
v_lshlrev_b32 v16, 2, v15
buffer_load_dword v56, v16, s[44:47], 0 offen
buffer_load_dword v57, v16, s[48:51], 0 offen
v_mov_b32 v58, 4
s_waitcnt vmcnt(0)
v_subrev_u32 v57, s58, v57
v_cmpx_gt_u32 vcc, s12, v57
v_lshlrev_b32 v18, 2, v57
ds_add_rtn_u32 v59, v18, v58 offset:0
s_waitcnt lgkmcnt(0)
v_and_b32 v58, 60, v18
v_xor_b32 v59, v59, v58
v_lshl_add_u32 v18, v18, 7, v59
v_lshlrev_b32 v56, 7, v56
v_lshlrev_b32 v15, 5, v15
ds_write2st64_b32 v18, v56, v15 offset0:10 offset1:94
s_mov_b64 exec, -1
Lsf_18:
s_branch L_build
L_epi:
s_cmp_ge_u32 s52, 5
s_cbranch_scc1 K2_fin
v_lshrrev_b32 v1, 3, v0
v_and_b32 v2, 7, v0
v_lshlrev_b32 v2, 5, v2
v_lshl_add_u32 v1, v1, 9, v2
ds_read_b128 v[208:211], v1 offset:45824
ds_read_b128 v[212:215], v1 offset:45840
s_mov_b32 s60, 0x358637bd
v_add_f32 v40, s60, v40
v_add_f32 v41, s60, v41
v_add_f32 v42, s60, v42
v_add_f32 v43, s60, v43
v_add_f32 v44, s60, v44
v_add_f32 v45, s60, v45
v_add_f32 v46, s60, v46
v_add_f32 v47, s60, v47
v_rcp_f32 v40, v40
v_rcp_f32 v41, v41
v_rcp_f32 v42, v42
v_rcp_f32 v43, v43
v_rcp_f32 v44, v44
v_rcp_f32 v45, v45
v_rcp_f32 v46, v46
v_rcp_f32 v47, v47
s_waitcnt lgkmcnt(0)
v_fma_f32 v208, v48, v40, v208
v_fma_f32 v209, v49, v41, v209
v_fma_f32 v210, v50, v42, v210
v_fma_f32 v211, v51, v43, v211
v_fma_f32 v212, v52, v44, v212
v_fma_f32 v213, v53, v45, v213
v_fma_f32 v214, v54, v46, v214
v_fma_f32 v215, v55, v47, v215
v_mul_f32 v48, 0, v208
v_cmp_lt_f32 vcc, 0, v208
s_nop 1
v_cndmask_b32 v208, v48, v208, vcc
v_mul_f32 v49, 0, v209
v_cmp_lt_f32 vcc, 0, v209
s_nop 1
v_cndmask_b32 v209, v49, v209, vcc
v_mul_f32 v50, 0, v210
v_cmp_lt_f32 vcc, 0, v210
s_nop 1
v_cndmask_b32 v210, v50, v210, vcc
v_mul_f32 v51, 0, v211
v_cmp_lt_f32 vcc, 0, v211
s_nop 1
v_cndmask_b32 v211, v51, v211, vcc
v_mul_f32 v52, 0, v212
v_cmp_lt_f32 vcc, 0, v212
s_nop 1
v_cndmask_b32 v212, v52, v212, vcc
v_mul_f32 v53, 0, v213
v_cmp_lt_f32 vcc, 0, v213
s_nop 1
v_cndmask_b32 v213, v53, v213, vcc
v_mul_f32 v54, 0, v214
v_cmp_lt_f32 vcc, 0, v214
s_nop 1
v_cndmask_b32 v214, v54, v214, vcc
v_mul_f32 v55, 0, v215
v_cmp_lt_f32 vcc, 0, v215
s_nop 1
v_cndmask_b32 v215, v55, v215, vcc
v_lshlrev_b32 v48, 16, v60
v_and_b32 v49, 0xffff0000, v60
v_add_f32 v48, v48, v208
v_add_f32 v49, v49, v209
v_cvt_pk_bf16_f32 v40, v48, v49
v_lshlrev_b32 v48, 16, v61
v_and_b32 v49, 0xffff0000, v61
v_add_f32 v48, v48, v210
v_add_f32 v49, v49, v211
v_cvt_pk_bf16_f32 v41, v48, v49
v_lshlrev_b32 v48, 16, v62
v_and_b32 v49, 0xffff0000, v62
v_add_f32 v48, v48, v212
v_add_f32 v49, v49, v213
v_cvt_pk_bf16_f32 v42, v48, v49
v_lshlrev_b32 v48, 16, v63
v_and_b32 v49, 0xffff0000, v63
v_add_f32 v48, v48, v214
v_add_f32 v49, v49, v215
v_cvt_pk_bf16_f32 v43, v48, v49
v_lshlrev_b32 v1, 4, v0
s_lshl_b32 s60, s58, 7
buffer_store_dwordx4 v[40:43], v1, s[40:43], s60 offen
K2_fin:
K2_end:
s_endpgm
.section .rodata,"a"
.p2align 6
.amdhsa_kernel gather_scatter__edge_featured_mpnn_gatedgcn__graph_kernel
  .amdhsa_next_free_vgpr 240
  .amdhsa_next_free_sgpr 102
  .amdhsa_accum_offset 240
  .amdhsa_group_segment_fixed_size 0
  .amdhsa_kernarg_size 96
  .amdhsa_user_sgpr_count 2
  .amdhsa_user_sgpr_kernarg_segment_ptr 1
  .amdhsa_system_sgpr_workgroup_id_x 1
  .amdhsa_float_denorm_mode_32 3
.end_amdhsa_kernel
.text
```
